```python
import torch

def _softmax(x, axis=-1):
    return torch.softmax(x, dim=axis)
def _gelu(x):
    return torch.nn.functional.gelu(x, approximate="tanh")
def _silu(x):
    return torch.nn.functional.silu(x)
def _sigmoid(x):
    return torch.sigmoid(x)
def _layernorm(x, axis=-1, eps=1e-5):
    m = x.mean(dim=axis, keepdim=True)
    v = x.var(dim=axis, keepdim=True, unbiased=False)
    return (x - m) / torch.sqrt(v + eps)
def _scatter_add(tgt, idx, src, axis=0):
    return tgt.clone().index_add_(axis, idx, src)
def _segment_sum(src, seg, n):
    out = torch.zeros((n,) + src.shape[1:], dtype=src.dtype)
    return out.index_add_(0, seg, src)
def _pad(x, pw):
    flat = tuple(v for pair in reversed(pw) for v in pair)
    return torch.nn.functional.pad(x, flat)

kernel_name = 'gated_mix__sliding_block_cached__geglu_ffn__decode'

def setup_inputs():

    _w = (lambda a: (lambda t: t.to(torch.bfloat16) if t.is_floating_point() else t)(torch.as_tensor(a)))
    def _A_setup():
        B, Sq, D = 2, 1, 640
        Hq, Hkv, Sk, Dh = 32, 32, 8192, 128
        assert Hq % Hkv == 0, (Hq, Hkv)
        return {
            "x": _w((lambda *s: torch.randn(*s, dtype=torch.bfloat16) * 0.05)(B, Sq, D)),
            "k_cache": _w((lambda *s: torch.randn(*s, dtype=torch.bfloat16) * 6.4)(B, Hkv, Sk, Dh)),
            "v_cache": _w((lambda *s: torch.randn(*s, dtype=torch.bfloat16) * 0.2)(B, Hkv, Sk, Dh)),
            "wq": _w((lambda *s: torch.randn(*s, dtype=torch.bfloat16) * 6.4)(D, Hq * Dh) * (D ** -0.5)),
            "wo": _w((lambda *s: torch.randn(*s, dtype=torch.bfloat16) * 0.2)(Hq * Dh, D) * ((Hq * Dh) ** -0.5)),
        }
    _A_in = _A_setup()

    def _B_setup():
        B, S, D, F = 2, 1, 640, 1728
        return {
            "x": _w((lambda *s: torch.randn(*s, dtype=torch.bfloat16) * 0.05)(B, S, D)),
            "w_gate": _w((lambda *s: torch.randn(*s, dtype=torch.bfloat16) * 0.05)(D, F)),
            "w_up": _w((lambda *s: torch.randn(*s, dtype=torch.bfloat16) * 0.05)(D, F)),
            "w_down": _w((lambda *s: torch.randn(*s, dtype=torch.bfloat16) * 0.05)(F, D)),
        }
    _B_in = _B_setup()

    return {
        "A_x": _A_in["x"],
        "A_k_cache": _A_in["k_cache"],
        "A_v_cache": _A_in["v_cache"],
        "A_wq": _A_in["wq"],
        "A_wo": _A_in["wo"],
        "B_x": _B_in["x"],
        "B_w_gate": _B_in["w_gate"],
        "B_w_up": _B_in["w_up"],
        "B_w_down": _B_in["w_down"],
        "gate_w": _w((lambda *s: torch.randn(*s, dtype=torch.bfloat16) * 0.05)(640) * 16.0),
    }

def reference(A_x, A_k_cache, A_v_cache, A_wq, A_wo, B_x, B_w_gate, B_w_up, B_w_down, gate_w):
    def _A_ref(x, k_cache, v_cache, wq, wo):
        B, Sq, D = x.shape
        Hq, Dh = 32, 128
        Hkv, Sk = k_cache.shape[1], k_cache.shape[2]
        W = min(4096, max(256, Sk // 4))
        rep = Hq // Hkv
        q = (lambda x, *d: x.permute(*d))((x @ wq).reshape(B, Sq, Hq, Dh), 0, 2, 1, 3)
        k = (lambda x, n, axis: torch.repeat_interleave(x, n, dim=axis))(k_cache[:, :, Sk - W:, :], rep, axis=1)
        v = (lambda x, n, axis: torch.repeat_interleave(x, n, dim=axis))(v_cache[:, :, Sk - W:, :], rep, axis=1)
        scores = torch.einsum("bhqd,bhkd->bhqk", q, k) * (Dh ** -0.5)
        p = _softmax(scores, axis=-1)
        o = torch.einsum("bhqk,bhkd->bhqd", p, v)
        return (lambda x, *d: x.permute(*d))(o, 0, 2, 1, 3).reshape(B, Sq, Hq * Dh) @ wo

    def _B_ref(x, w_gate, w_up, w_down):
        return (_gelu(x @ w_gate) * (x @ w_up)) @ w_down

    x = A_x
    g = _sigmoid((x * gate_w).sum(-1, keepdims=True))
    a = _A_ref(x, A_k_cache, A_v_cache, A_wq, A_wo)
    b = _B_ref(x, B_w_gate, B_w_up, B_w_down)
    return g * a + (1 - g) * b
```

```asm
; @launch grid=(256,1,1) block=(256,1,1) lds=8704
.amdgcn_target "amdgcn-amd-amdhsa--gfx950"
.text
.globl gated_mix__sliding_block_cached__geglu_ffn__decode_kernel
.p2align 12
.p2align 8
.type gated_mix__sliding_block_cached__geglu_ffn__decode_kernel,@function
gated_mix__sliding_block_cached__geglu_ffn__decode_kernel:
    s_load_dwordx2 s[44:45], s[0:1], 8
    s_cmpk_ge_u32 s2, 0x100
    s_cbranch_scc1 L_exit
    v_lshrrev_b32 v1, 6, v0
    s_getpc_b64 s[30:31]
L_pc:
    s_lshr_b32 s3, s2, 3
    s_lshl_b32 s3, s3, 9
    v_lshl_add_u32 v3, v1, 7, s3
    v_min_u32 v3, L_last-L_pc-256, v3
    global_load_dword v3, v3, s[30:31] offset:256
    v_and_b32 v0, 63, v0
    v_readfirstlane_b32 s34, v1
    s_and_b32 s32, s2, 31
    s_lshr_b32 s33, s2, 5
    v_lshrrev_b32 v1, 4, v0
    v_and_b32 v2, 15, v0
    s_mov_b32 s52, 0x76243501
    s_mov_b32 s53, 0x76453201
    s_bitcmp1_b32 s32, 4
    s_cselect_b32 s52, 0x75643201, s52
    s_cselect_b32 s53, 0x26543701, s53
    s_lshl_b32 s3, s32, 2
    s_lshr_b64 s[52:53], s[52:53], s3
    s_and_b32 s52, s52, 7
    s_and_b32 s65, s32, 24
    s_or_b32 s65, s65, s52
    s_brev_b32 s46, 16
    s_mov_b32 s47, 0x20000
    s_mov_b64 s[50:51], s[46:47]
    s_lshr_b32 s3, s33, 2
    s_lshl_b32 s3, s3, 5
    s_add_u32 s3, s3, s65
    s_lshl_b32 s3, s3, 4
    s_or_b32 s67, s33, 12
    s_or_b32 s3, s3, s67
    s_lshl_b32 s3, s3, 7
    s_add_u32 s3, s3, s34
    s_lshl_b32 s3, s3, 10
    v_lshl_add_u32 v12, v2, 2, v1
    v_lshl_add_u32 v12, v12, 4, s3
    v_lshl_add_u32 v13, v0, 4, s3
    s_mul_i32 s3, s32, 5
    s_mul_i32 s67, s33, 3
    s_add_u32 s3, s3, s67
    s_and_b32 s3, s3, 31
    s_lshl_b32 s3, s3, 12
    s_lshr_b32 s41, s32, 3
    s_sub_u32 s40, s32, s41
    s_sub_u32 s40, s40, 1
    s_cmp_eq_u32 s32, 31
    s_cselect_b32 s40, 25, s40
    s_cmp_eq_u32 s32, 29
    s_cselect_b32 s40, 27, s40
    s_and_b32 s41, s32, 7
    s_cselect_b32 s40, s40, 28
    s_lshr_b32 s35, s33, 1
    s_lshl_b32 s35, s35, 2
    s_add_u32 s35, s35, s34
    s_mulk_i32 s35, 40
    v_mad_u32_u24 v40, v1, 10, s35
    s_and_b32 s41, s33, 1
    s_lshl_b32 s78, s65, 1
    s_add_u32 s78, s78, s41
    s_lshl_b32 s78, s78, 7
    s_lshl_b32 s79, s40, 7
    s_mov_b32 vcc_lo, 0xff00ff00
    s_mov_b32 vcc_hi, vcc_lo
    v_mov_b32 v38, 0x2000
    v_mov_b32 v39, 3456
    v_cndmask_b32 v38, v38, v39, vcc
    v_mov_b32 v39, 0
    v_mov_b32 v41, s78
    v_mov_b32 v42, s79
    v_cndmask_b32 v41, v41, v42, vcc
    v_and_b32 v42, 7, v2
    v_lshl_add_u32 v41, v42, 4, v41
    v_mad_u32_u24 v36, v40, v38, v41
    v_mov_b32 v37, 0
    v_lshrrev_b32 v44, 3, v2
    v_mul_u32_u24 v44, 1280, v44
    v_lshl_add_u32 v44, v40, 1, v44
    s_cmp_eq_u32 s41, 0
    s_cbranch_scc1 L_fwd
    v_mad_u32_u24 v36, v38, 9, v36
    v_sub_u32 v38, 0, v38
    v_mov_b32 v39, -1
L_fwd:
    s_waitcnt lgkmcnt(0)
    s_load_dwordx16 s[4:19], s[0:1], 0
    buffer_load_dwordx4 a[0:3], v12, s[44:47], s3 offen nt
    s_addk_i32 s3, 4096
    s_bitset0_b32 s3, 17
    s_waitcnt lgkmcnt(0)
    s_load_dwordx8 s[20:27], s[0:1], 64
    s_load_dwordx2 s[28:29], s[0:1], 96
    s_cmp_eq_u32 s41, 0
    s_cselect_b64 s[16:17], s[16:17], s[18:19]
    v_mov_b32 v34, s10
    v_mov_b32 v35, s11
    v_mov_b32 v32, s16
    v_mov_b32 v33, s17
    v_cndmask_b32 v34, v34, v32, vcc
    v_cndmask_b32 v35, v35, v33, vcc
    s_not_b64 s[42:43], vcc
    s_cmp_ge_u32 s40, 27
    s_cselect_b64 s[42:43], s[42:43], -1
    v_lshl_add_u64 v[36:37], v[36:37], 0, v[34:35]
    s_mov_b64 exec, s[42:43]
    global_load_dwordx4 v[64:67], v[36:37], off nt
    v_lshl_add_u64 v[36:37], v[36:37], 0, v[38:39]
    global_load_dwordx4 v[68:71], v[36:37], off nt
    v_lshl_add_u64 v[36:37], v[36:37], 0, v[38:39]
    global_load_dwordx4 v[72:75], v[36:37], off nt
    v_lshl_add_u64 v[36:37], v[36:37], 0, v[38:39]
    global_load_dwordx4 v[76:79], v[36:37], off nt
    v_lshl_add_u64 v[36:37], v[36:37], 0, v[38:39]
    global_load_dwordx4 v[80:83], v[36:37], off nt
    v_lshl_add_u64 v[36:37], v[36:37], 0, v[38:39]
    global_load_dwordx4 v[84:87], v[36:37], off nt
    v_lshl_add_u64 v[36:37], v[36:37], 0, v[38:39]
    global_load_dwordx4 v[88:91], v[36:37], off nt
    v_lshl_add_u64 v[36:37], v[36:37], 0, v[38:39]
    global_load_dwordx4 v[92:95], v[36:37], off nt
    v_lshl_add_u64 v[36:37], v[36:37], 0, v[38:39]
    global_load_dwordx4 v[96:99], v[36:37], off nt
    v_lshl_add_u64 v[36:37], v[36:37], 0, v[38:39]
    global_load_dwordx4 v[100:103], v[36:37], off nt
    s_mov_b64 exec, -1
    global_load_dwordx4 v[16:19], v44, s[4:5]
    global_load_dword v20, v44, s[4:5] offset:16
    s_mov_b64 s[48:49], s[8:9]
    s_waitcnt lgkmcnt(0)
    s_load_dwordx4 s[36:39], s[28:29], 0
    s_lshl_b32 s14, s2, 2
    s_add_u32 s14, s14, s34
    s_sub_u32 s14, s14, 898
    s_cmp_eq_u32 s14, 32
    s_cbranch_scc1 L_nopl_do
L_nopl:
    buffer_load_dwordx4 a[4:7], v12, s[44:47], s3 offen nt
    s_addk_i32 s3, 4096
    s_bitset0_b32 s3, 17
    buffer_load_dwordx4 a[8:11], v12, s[44:47], s3 offen nt
    s_addk_i32 s3, 4096
    s_bitset0_b32 s3, 17
    buffer_load_dwordx4 a[12:15], v12, s[44:47], s3 offen nt
    s_addk_i32 s3, 4096
    s_bitset0_b32 s3, 17
    v_mul_u32_u24 v14, 20480, v1
    v_lshl_add_u32 v14, v2, 4, v14
    s_mov_b32 s55, 0x20000
    s_mov_b32 s77, 1000000
    s_movk_i32 s76, 0xfc00
    s_cmp_ge_u32 s33, 5
    s_cbranch_scc1 L_role1
    s_mov_b32 s64, 0
    s_mov_b64 s[52:53], s[12:13]
    s_mov_b32 s54, 5242880
    s_lshl_b32 s66, s65, 1
    s_and_b32 s78, s34, 1
    s_add_u32 s66, s66, s78
    s_lshl_b32 s66, s66, 4
    s_lshr_b32 s78, s34, 1
    s_add_u32 s66, s66, s78
    s_mulk_i32 s66, 5120
    s_mov_b32 s65, s33
    s_branch L_role2
L_role1:
    s_mov_b64 s[52:53], s[20:21]
    s_mov_b32 s54, 0
    s_mov_b32 s64, 3
    s_mov_b32 s65, 0
    s_mov_b32 s66, 0
    s_cmp_ge_u32 s40, 27
    s_cbranch_scc1 L_role2
    s_mov_b32 s64, 2
    s_sub_u32 s78, s33, 5
    s_lshl_b32 s78, s78, 2
    s_add_u32 s78, s78, s34
    s_cmp_ge_u32 s78, 10
    s_cbranch_scc1 L_role2
    s_lshr_b32 s65, s78, 1
    s_lshl_b32 s66, s40, 4
    s_and_b32 s79, s78, 1
    s_add_u32 s66, s66, s79
    s_mulk_i32 s66, 5120
    s_mov_b32 s64, 1
    s_mov_b32 s54, 2211840
L_role2:
    s_lshl_b32 s78, s65, 8
    s_add_u32 s66, s66, s78
    s_add_u32 s67, s66, 10240
    s_mov_b64 s[56:57], s[24:25]
    s_movk_i32 s58, 2560
    s_mov_b32 s59, 0x20000
    s_lshl_b32 s15, s33, 1
    s_sub_u32 s15, 19, s15
    s_add_u32 s15, s15, s34
    s_add_u32 s78, s34, 1
    s_bitcmp1_b32 s78, 1
    s_cselect_b32 s15, s15, 63
    s_lshl_b32 s78, s33, 2
    s_sub_u32 s78, 28, s78
    s_add_u32 s78, s78, s34
    s_cmp_ge_u32 s33, 5
    s_cselect_b32 s15, s78, s15
    s_and_b32 s78, s32, 7
    s_cmp_eq_u32 s78, 0
    s_cselect_b32 s15, s15, 63
    buffer_load_dwordx4 a[16:19], v12, s[44:47], s3 offen nt
    s_addk_i32 s3, 4096
    s_bitset0_b32 s3, 17
    buffer_load_dwordx4 a[20:23], v12, s[44:47], s3 offen nt
    s_addk_i32 s3, 4096
    s_bitset0_b32 s3, 17
    buffer_load_dwordx4 a[24:27], v12, s[44:47], s3 offen nt
    s_addk_i32 s3, 4096
    s_bitset0_b32 s3, 17
    s_mov_b32 s31, 0
    v_and_b32 v8, 3, v2
    v_lshlrev_b32 v8, 4, v8
    v_mov_b32 v10, 0xffff
    v_mov_b32 v11, 0
    v_lshlrev_b64 v[10:11], v8, v[10:11]
    s_mov_b32 vcc_lo, 0x0f0f0f0f
    s_mov_b32 vcc_hi, vcc_lo
    v_cndmask_b32 v4, 0, v10, vcc
    v_cndmask_b32 v5, 0, v11, vcc
    v_xor_b32 v6, v4, v10
    v_xor_b32 v7, v5, v11
    v_lshlrev_b32 v15, 4, v0
    s_mov_b32 s68, 0x000f000f
    s_mov_b32 s69, s68
    s_lshl_b64 s[70:71], s[68:69], 4
    s_lshl_b64 s[72:73], s[68:69], 8
    s_lshl_b64 s[74:75], s[68:69], 12
    s_mov_b32 s78, 0x01000100
    s_mov_b32 s79, 0x03020302
    s_cmp_eq_u32 s41, 0
    s_cselect_b32 s78, s78, 0x07060706
    s_cselect_b32 s79, s79, 0x05040504
    s_lshl_b32 s35, s34, 10
    v_lshl_add_u32 v47, v0, 4, s35
    v_mov_b32 v52, 0
    v_mov_b32 v53, 0
    s_lshl_b32 s35, s34, 3
    v_mov_b32 v54, s35
    ds_write_b64 v54, v[52:53] offset:8192
    buffer_load_dwordx4 a[28:31], v12, s[44:47], s3 offen nt
    s_addk_i32 s3, 4096
    s_bitset0_b32 s3, 17
    buffer_load_dwordx4 a[32:35], v12, s[44:47], s3 offen nt
    s_addk_i32 s3, 4096
    s_bitset0_b32 s3, 17
    buffer_load_dwordx4 a[36:39], v12, s[44:47], s3 offen nt
    s_addk_i32 s3, 4096
    s_bitset0_b32 s3, 17
    buffer_load_dwordx4 a[40:43], v12, s[44:47], s3 offen nt
    s_addk_i32 s3, 4096
    s_bitset0_b32 s3, 17
    buffer_load_dwordx4 a[44:47], v12, s[44:47], s3 offen nt
    s_addk_i32 s3, 4096
    s_bitset0_b32 s3, 17
    buffer_load_dwordx4 a[48:51], v12, s[44:47], s3 offen nt
    s_addk_i32 s3, 4096
    s_bitset0_b32 s3, 17
    s_waitcnt vmcnt(12)
    v_perm_b32 v21, v20, v16, s78
    v_and_b32 v56, v21, v4
    v_and_b32 v57, v21, v5
    v_and_b32 v58, v21, v6
    v_and_b32 v59, v21, v7
    v_perm_b32 v21, v20, v16, s79
    v_and_b32 v60, v21, v4
    v_and_b32 v61, v21, v5
    v_and_b32 v62, v21, v6
    v_and_b32 v63, v21, v7
    v_mfma_f32_16x16x32_bf16 v[32:35], v[56:59], v[64:67], 0
    v_perm_b32 v21, v19, v17, s78
    v_and_b32 v56, v21, v4
    v_and_b32 v57, v21, v5
    v_and_b32 v58, v21, v6
    v_and_b32 v59, v21, v7
    v_mfma_f32_16x16x32_bf16 v[32:35], v[60:63], v[68:71], v[32:35]
    v_perm_b32 v21, v19, v17, s79
    v_and_b32 v60, v21, v4
    v_and_b32 v61, v21, v5
    v_and_b32 v62, v21, v6
    v_and_b32 v63, v21, v7
    v_mfma_f32_16x16x32_bf16 v[32:35], v[56:59], v[72:75], v[32:35]
    v_perm_b32 v21, v18, v18, s78
    v_and_b32 v56, v21, v4
    v_and_b32 v57, v21, v5
    v_and_b32 v58, v21, v6
    v_and_b32 v59, v21, v7
    v_mfma_f32_16x16x32_bf16 v[32:35], v[60:63], v[76:79], v[32:35]
    v_perm_b32 v21, v18, v18, s79
    v_and_b32 v60, v21, v4
    v_and_b32 v61, v21, v5
    v_and_b32 v62, v21, v6
    v_and_b32 v63, v21, v7
    v_mfma_f32_16x16x32_bf16 v[32:35], v[56:59], v[80:83], v[32:35]
    v_perm_b32 v21, v17, v19, s78
    v_and_b32 v56, v21, v4
    v_and_b32 v57, v21, v5
    v_and_b32 v58, v21, v6
    v_and_b32 v59, v21, v7
    v_mfma_f32_16x16x32_bf16 v[32:35], v[60:63], v[84:87], v[32:35]
    v_perm_b32 v21, v17, v19, s79
    v_and_b32 v60, v21, v4
    v_and_b32 v61, v21, v5
    v_and_b32 v62, v21, v6
    v_and_b32 v63, v21, v7
    v_mfma_f32_16x16x32_bf16 v[32:35], v[56:59], v[88:91], v[32:35]
    v_perm_b32 v21, v16, v20, s78
    v_and_b32 v56, v21, v4
    v_and_b32 v57, v21, v5
    v_and_b32 v58, v21, v6
    v_and_b32 v59, v21, v7
    v_mfma_f32_16x16x32_bf16 v[32:35], v[60:63], v[92:95], v[32:35]
    v_perm_b32 v21, v16, v20, s79
    v_and_b32 v60, v21, v4
    v_and_b32 v61, v21, v5
    v_and_b32 v62, v21, v6
    v_and_b32 v63, v21, v7
    v_mfma_f32_16x16x32_bf16 v[32:35], v[56:59], v[96:99], v[32:35]
    s_nop 0
    v_mfma_f32_16x16x32_bf16 v[32:35], v[60:63], v[100:103], v[32:35]
    buffer_load_dwordx4 a[52:55], v12, s[44:47], s3 offen nt
    s_addk_i32 s3, 4096
    s_bitset0_b32 s3, 17
    s_nop 4
    ds_write_b128 v47, v[32:35]
    s_waitcnt lgkmcnt(0)
    s_barrier
    s_add_u32 s36, s36, 1
    s_add_u32 s37, s37, 1
    s_add_u32 s38, s38, 2
    s_add_u32 s39, s39, 1
    s_lshr_b32 s61, s36, 10
    s_add_u32 s61, s61, s36
    s_lshr_b32 s62, s36, 20
    s_add_u32 s62, s62, s36
    s_andn2_b32 s60, s36, s76
    v_mov_b32 v8, s60
    s_andn2_b32 s61, s61, s76
    v_mov_b32 v9, s61
    s_andn2_b32 s62, s62, s76
    v_mov_b32 v10, s62
    s_andn2_b32 s63, s39, s76
    v_mov_b32 v11, s63
    s_getreg_b32 s30, hwreg(HW_REG_XCC_ID, 0, 4)
    s_and_b32 s24, s60, 15
    s_and_b32 s25, s61, 15
    s_and_b32 s26, s62, 15
    s_and_b32 s27, s63, 15
    s_lshl_b32 s35, s32, 3
    s_add_u32 s35, s35, s33
    s_lshl_b32 s35, s35, 10
    s_add_u32 s35, s35, 65536
    v_add_u32 v36, s35, v15
    s_cmp_eq_u32 s34, 1
    s_cbranch_scc0 L_noApub
    v_lshlrev_b32 v3, 4, v0
    ds_read_b128 v[16:19], v3 offset:0
    ds_read_b128 v[20:23], v3 offset:2048
    ds_read_b128 v[24:27], v3 offset:3072
    s_mov_b32 vcc_lo, 0xff00ff00
    s_mov_b32 vcc_hi, vcc_lo
    v_mov_b32 v3, s30
    v_mov_b32 v37, s27
    v_cndmask_b32 v3, v3, v37, vcc
    s_waitcnt lgkmcnt(0)
    v_pk_add_f32 v[32:33], v[16:17], v[32:33]
    v_pk_add_f32 v[34:35], v[18:19], v[34:35]
    v_pk_add_f32 v[20:21], v[20:21], v[24:25]
    v_pk_add_f32 v[22:23], v[22:23], v[26:27]
    v_pk_add_f32 v[32:33], v[32:33], v[20:21]
    v_pk_add_f32 v[34:35], v[34:35], v[22:23]
    v_and_or_b32 v32, v32, -16, s24
    v_and_or_b32 v33, v33, -16, s25
    v_and_or_b32 v34, v34, -16, s26
    v_and_or_b32 v35, v35, -16, v3
    s_mov_b64 exec, s[42:43]
    global_store_dwordx4 v36, v[32:35], s[28:29]
    s_mov_b64 exec, -1
L_noApub:
    buffer_load_dwordx4 a[56:59], v12, s[44:47], s3 offen nt
    s_addk_i32 s3, 4096
    s_bitset0_b32 s3, 17
    buffer_load_dwordx4 a[60:63], v12, s[44:47], s3 offen nt
    s_addk_i32 s3, 4096
    s_bitset0_b32 s3, 17
    s_lshl_b32 s35, s32, 13
    s_add_u32 s35, s35, 65664
    s_and_b32 s78, s34, 1
    s_lshl_b32 s78, s78, 8
    s_add_u32 s78, s78, s35
    v_and_b32 v40, 3, v2
    v_lshlrev_b32 v38, 11, v40
    v_lshrrev_b32 v16, 3, v2
    v_lshl_add_u32 v38, v16, 9, v38
    v_lshl_add_u32 v38, v1, 5, v38
    v_and_b32 v16, 4, v2
    v_lshl_add_u32 v38, v16, 2, v38
    v_add_u32 v38, s78, v38
    s_lshr_b32 s78, s33, 2
    s_lshl_b32 s78, s78, 9
    s_add_u32 s35, s35, s78
    s_addk_i32 s35, 1920
    v_and_b32 v16, 8, v2
    v_and_b32 v17, 7, v2
    v_lshl_add_u32 v3, v1, 6, v2
    v_add_u32 v3, v3, v16
    v_lshl_add_u32 v3, v3, 4, s35
    v_lshl_add_u32 v39, v17, 4, v16
    v_and_b32 v17, 1, v1
    v_lshl_add_u32 v39, v17, 7, v39
    v_lshrrev_b32 v17, 1, v1
    v_lshl_add_u32 v39, v17, 2, v39
    v_lshlrev_b32 v40, 6, v40
    v_lshl_add_u32 v40, v1, 4, v40
    s_cmp_eq_u32 s14, 0
    s_cbranch_scc1 L_ng1_do
L_ng1:
    buffer_load_dwordx4 a[64:67], v12, s[44:47], s3 offen nt
    s_addk_i32 s3, 4096
    s_bitset0_b32 s3, 17
    buffer_load_dwordx4 a[68:71], v12, s[44:47], s3 offen nt
    s_addk_i32 s3, 4096
    s_bitset0_b32 s3, 17
    buffer_load_dwordx4 a[72:75], v12, s[44:47], s3 offen nt
    s_addk_i32 s3, 4096
    s_bitset0_b32 s3, 17
    buffer_load_dwordx4 a[76:79], v12, s[44:47], s3 offen nt
    s_addk_i32 s3, 4096
    s_bitset0_b32 s3, 17
    buffer_load_dwordx4 a[80:83], v12, s[44:47], s3 offen nt
    s_addk_i32 s3, 4096
    s_bitset0_b32 s3, 17
    buffer_load_dwordx4 a[84:87], v12, s[44:47], s3 offen nt
    s_addk_i32 s3, 4096
    s_bitset0_b32 s3, 17
    buffer_load_dwordx4 a[88:91], v12, s[44:47], s3 offen nt
    s_addk_i32 s3, 4096
    s_bitset0_b32 s3, 17
    buffer_load_dwordx4 a[92:95], v12, s[44:47], s3 offen nt
    s_addk_i32 s3, 4096
    s_bitset0_b32 s3, 17
    buffer_load_dwordx4 a[96:99], v12, s[44:47], s3 offen nt
    s_addk_i32 s3, 4096
    s_bitset0_b32 s3, 17
    buffer_load_dwordx4 a[100:103], v12, s[44:47], s3 offen nt
    s_addk_i32 s3, 4096
    s_bitset0_b32 s3, 17
    s_cmp_eq_u32 s34, 1
    s_cbranch_scc0 L_noqp
    global_load_dwordx4 v[16:19], v3, s[28:29] offset:-2048 sc1
    global_load_dwordx4 v[20:23], v3, s[28:29] offset:2048 sc1
L_noqp:
    s_cmp_eq_u32 s64, 2
    s_cbranch_scc1 L_nogp_do
L_nogp:
    buffer_load_dwordx4 a[104:107], v12, s[44:47], s3 offen nt
    s_addk_i32 s3, 4096
    s_bitset0_b32 s3, 17
    buffer_load_dwordx4 a[108:111], v12, s[44:47], s3 offen nt
    s_addk_i32 s3, 4096
    s_bitset0_b32 s3, 17
    buffer_load_dwordx4 a[112:115], v12, s[44:47], s3 offen nt
    s_addk_i32 s3, 4096
    s_bitset0_b32 s3, 17
    s_cmp_eq_u32 s14, 0
    s_cbranch_scc1 L_ng2_do
L_ng2:
    buffer_load_dwordx4 a[116:119], v12, s[44:47], s3 offen nt
    s_addk_i32 s3, 4096
    s_bitset0_b32 s3, 17
    buffer_load_dwordx4 a[120:123], v12, s[44:47], s3 offen nt
    s_addk_i32 s3, 4096
    s_bitset0_b32 s3, 17
    buffer_load_dwordx4 a[124:127], v12, s[44:47], s3 offen nt
    s_addk_i32 s3, 4096
    s_bitset0_b32 s3, 17
    buffer_load_dwordx4 v[64:67], v13, s[48:51], s3 offen nt
    s_addk_i32 s3, 4096
    s_bitset0_b32 s3, 17
    buffer_load_dwordx4 v[68:71], v13, s[48:51], s3 offen nt
    s_addk_i32 s3, 4096
    s_bitset0_b32 s3, 17
    buffer_load_dwordx4 v[72:75], v13, s[48:51], s3 offen nt
    s_addk_i32 s3, 4096
    s_bitset0_b32 s3, 17
    buffer_load_dwordx4 v[76:79], v13, s[48:51], s3 offen nt
    s_addk_i32 s3, 4096
    s_bitset0_b32 s3, 17
    buffer_load_dwordx4 v[80:83], v13, s[48:51], s3 offen nt
    s_addk_i32 s3, 4096
    s_bitset0_b32 s3, 17
    buffer_load_dwordx4 v[84:87], v13, s[48:51], s3 offen nt
    s_addk_i32 s3, 4096
    s_bitset0_b32 s3, 17
    s_cmp_eq_u32 s34, 1
    s_cbranch_scc0 L_noq
    s_waitcnt vmcnt(12)
L_qchk:
    v_xor_b32 v16, s24, v16
    v_xor_b32 v17, s25, v17
    v_xor_b32 v18, s26, v18
    v_xor_b32 v19, s30, v19
    v_xor_b32 v20, s24, v20
    v_xor_b32 v21, s25, v21
    v_xor_b32 v22, s26, v22
    v_xor_b32 v23, s30, v23
    v_or3_b32 v37, v16, v17, v18
    v_or3_b32 v37, v37, v19, v20
    v_or3_b32 v37, v37, v21, v22
    v_bitop3_b32 v37, v37, v23, -16 bitop3:0x54
    v_cmp_ne_u32 vcc, 0, v37
    s_cbranch_vccnz L_qslow
L_qok:
    v_pk_add_f32 v[16:17], v[16:17], v[20:21]
    v_pk_add_f32 v[18:19], v[18:19], v[22:23]
    v_mov_b32 v20, s31
    v_mov_b32 v21, 0
    v_permlane32_swap_b32 v16, v18
    v_permlane32_swap_b32 v17, v19
    v_add_f32 v16, v16, v18
    v_add_f32 v17, v17, v19
    v_cvt_pk_bf16_f32 v16, v16, v17
    ds_write_b32 v21, v20 offset:8512
    ds_write_b32 v39, v16 offset:8256
    s_waitcnt lgkmcnt(0)
L_noq:
    s_barrier
    v_mov_b32 v21, 0
    ds_read_b128 v[24:27], v40 offset:8256
    ds_read_b32 v20, v21 offset:8512
    buffer_load_dwordx4 v[88:91], v13, s[48:51], s3 offen nt
    s_addk_i32 s3, 4096
    s_bitset0_b32 s3, 17
    s_waitcnt lgkmcnt(0)
    v_readfirstlane_b32 s31, v20
    s_cmp_eq_u32 s64, 2
    s_cbranch_scc1 L_noh_do
L_noh:
    v_cndmask_b32_e64 v32, 0, v24, s[68:69]
    v_cndmask_b32_e64 v33, 0, v25, s[68:69]
    v_cndmask_b32_e64 v34, 0, v26, s[68:69]
    v_cndmask_b32_e64 v35, 0, v27, s[68:69]
    v_cndmask_b32_e64 v36, 0, v24, s[70:71]
    v_cndmask_b32_e64 v37, 0, v25, s[70:71]
    v_cndmask_b32_e64 v38, 0, v26, s[70:71]
    v_cndmask_b32_e64 v39, 0, v27, s[70:71]
    v_cndmask_b32_e64 v40, 0, v24, s[72:73]
    v_cndmask_b32_e64 v41, 0, v25, s[72:73]
    v_cndmask_b32_e64 v42, 0, v26, s[72:73]
    v_cndmask_b32_e64 v43, 0, v27, s[72:73]
    v_cndmask_b32_e64 v60, 0, v24, s[74:75]
    v_cndmask_b32_e64 v61, 0, v25, s[74:75]
    v_cndmask_b32_e64 v62, 0, v26, s[74:75]
    v_cndmask_b32_e64 v63, 0, v27, s[74:75]
    buffer_load_dwordx4 v[92:95], v13, s[48:51], s3 offen nt
    s_addk_i32 s3, 4096
    s_bitset0_b32 s3, 17
    s_waitcnt vmcnt(32)
    v_mfma_f32_16x16x32_bf16 v[16:19], a[0:3], v[32:35], 0
    v_mfma_f32_16x16x32_bf16 v[20:23], a[16:19], v[32:35], 0
    v_mfma_f32_16x16x32_bf16 v[16:19], a[4:7], v[36:39], v[16:19]
    v_mfma_f32_16x16x32_bf16 v[20:23], a[20:23], v[36:39], v[20:23]
    v_mfma_f32_16x16x32_bf16 v[16:19], a[8:11], v[40:43], v[16:19]
    v_mfma_f32_16x16x32_bf16 v[20:23], a[24:27], v[40:43], v[20:23]
    v_mfma_f32_16x16x32_bf16 v[16:19], a[12:15], v[60:63], v[16:19]
    v_mfma_f32_16x16x32_bf16 v[20:23], a[28:31], v[60:63], v[20:23]
    buffer_load_dwordx4 v[96:99], v13, s[48:51], s3 offen nt
    s_addk_i32 s3, 4096
    s_bitset0_b32 s3, 17
    s_waitcnt vmcnt(25)
    v_mfma_f32_16x16x32_bf16 v[24:27], a[32:35], v[32:35], 0
    v_mfma_f32_16x16x32_bf16 v[28:31], a[48:51], v[32:35], 0
    v_mfma_f32_16x16x32_bf16 v[24:27], a[36:39], v[36:39], v[24:27]
    v_mfma_f32_16x16x32_bf16 v[28:31], a[52:55], v[36:39], v[28:31]
    v_mov_b32_dpp v48, v16 quad_perm:[0,0,0,0] row_mask:0xf bank_mask:0xf
    v_mov_b32_dpp v49, v20 quad_perm:[0,0,0,0] row_mask:0xf bank_mask:0xf
    s_nop 0
    v_add_f32_dpp v48, v17, v48 quad_perm:[1,1,1,1] row_mask:0xf bank_mask:0xf
    v_add_f32_dpp v49, v21, v49 quad_perm:[1,1,1,1] row_mask:0xf bank_mask:0xf
    v_mfma_f32_16x16x32_bf16 v[24:27], a[40:43], v[40:43], v[24:27]
    v_add_f32_dpp v48, v18, v48 quad_perm:[2,2,2,2] row_mask:0xf bank_mask:0xf
    v_add_f32_dpp v49, v22, v49 quad_perm:[2,2,2,2] row_mask:0xf bank_mask:0xf
    s_nop 0
    v_add_f32_dpp v48, v19, v48 quad_perm:[3,3,3,3] row_mask:0xf bank_mask:0xf
    v_add_f32_dpp v49, v23, v49 quad_perm:[3,3,3,3] row_mask:0xf bank_mask:0xf
    v_mfma_f32_16x16x32_bf16 v[28:31], a[56:59], v[40:43], v[28:31]
    v_cvt_pk_bf16_f32 v56, v48, v49
    v_lshlrev_b32 v48, 16, v56
    v_and_b32 v49, 0xffff0000, v56
    v_mul_f32 v48, 0x3db504f3, v48
    v_mfma_f32_16x16x32_bf16 v[24:27], a[44:47], v[60:63], v[24:27]
    v_mul_f32 v49, 0x3db504f3, v49
    v_cvt_pk_bf16_f32 v56, v48, v49
    v_lshlrev_b32 v48, 16, v56
    v_and_b32 v49, 0xffff0000, v56
    v_mfma_f32_16x16x32_bf16 v[28:31], a[60:63], v[60:63], v[28:31]
    buffer_load_dwordx4 v[100:103], v13, s[48:51], s3 offen nt
    s_addk_i32 s3, 4096
    s_bitset0_b32 s3, 17
    s_waitcnt vmcnt(18)
    v_mfma_f32_16x16x32_bf16 v[16:19], a[64:67], v[32:35], 0
    v_mfma_f32_16x16x32_bf16 v[20:23], a[80:83], v[32:35], 0
    v_mfma_f32_16x16x32_bf16 v[16:19], a[68:71], v[36:39], v[16:19]
    v_mfma_f32_16x16x32_bf16 v[20:23], a[84:87], v[36:39], v[20:23]
    v_mov_b32_dpp v50, v24 quad_perm:[0,0,0,0] row_mask:0xf bank_mask:0xf
    v_mov_b32_dpp v51, v28 quad_perm:[0,0,0,0] row_mask:0xf bank_mask:0xf
    s_nop 0
    v_add_f32_dpp v50, v25, v50 quad_perm:[1,1,1,1] row_mask:0xf bank_mask:0xf
    v_add_f32_dpp v51, v29, v51 quad_perm:[1,1,1,1] row_mask:0xf bank_mask:0xf
    v_mfma_f32_16x16x32_bf16 v[16:19], a[72:75], v[40:43], v[16:19]
    v_add_f32_dpp v50, v26, v50 quad_perm:[2,2,2,2] row_mask:0xf bank_mask:0xf
    v_add_f32_dpp v51, v30, v51 quad_perm:[2,2,2,2] row_mask:0xf bank_mask:0xf
    s_nop 0
    v_add_f32_dpp v50, v27, v50 quad_perm:[3,3,3,3] row_mask:0xf bank_mask:0xf
    v_add_f32_dpp v51, v31, v51 quad_perm:[3,3,3,3] row_mask:0xf bank_mask:0xf
    v_mfma_f32_16x16x32_bf16 v[20:23], a[88:91], v[40:43], v[20:23]
    v_cvt_pk_bf16_f32 v56, v50, v51
    v_lshlrev_b32 v50, 16, v56
    v_and_b32 v51, 0xffff0000, v56
    v_mul_f32 v50, 0x3db504f3, v50
    v_mfma_f32_16x16x32_bf16 v[16:19], a[76:79], v[60:63], v[16:19]
    v_mul_f32 v51, 0x3db504f3, v51
    v_cvt_pk_bf16_f32 v56, v50, v51
    v_lshlrev_b32 v50, 16, v56
    v_and_b32 v51, 0xffff0000, v56
    v_mfma_f32_16x16x32_bf16 v[20:23], a[92:95], v[60:63], v[20:23]
    buffer_load_dwordx4 v[104:107], v13, s[48:51], s3 offen nt
    s_addk_i32 s3, 4096
    s_bitset0_b32 s3, 17
    buffer_load_dwordx4 v[108:111], v13, s[48:51], s3 offen nt
    s_addk_i32 s3, 4096
    s_bitset0_b32 s3, 17
    buffer_load_dwordx4 v[112:115], v13, s[48:51], s3 offen nt
    s_addk_i32 s3, 4096
    s_bitset0_b32 s3, 17
    buffer_load_dwordx4 v[116:119], v13, s[48:51], s3 offen nt
    s_addk_i32 s3, 4096
    s_bitset0_b32 s3, 17
    buffer_load_dwordx4 v[120:123], v13, s[48:51], s3 offen nt
    s_addk_i32 s3, 4096
    s_bitset0_b32 s3, 17
    buffer_load_dwordx4 v[124:127], v13, s[48:51], s3 offen nt
    s_addk_i32 s3, 4096
    s_bitset0_b32 s3, 17
    s_waitcnt vmcnt(16)
    v_mfma_f32_16x16x32_bf16 v[24:27], a[96:99], v[32:35], 0
    v_mfma_f32_16x16x32_bf16 v[28:31], a[112:115], v[32:35], 0
    v_mfma_f32_16x16x32_bf16 v[24:27], a[100:103], v[36:39], v[24:27]
    v_mfma_f32_16x16x32_bf16 v[28:31], a[116:119], v[36:39], v[28:31]
    v_mov_b32_dpp v52, v16 quad_perm:[0,0,0,0] row_mask:0xf bank_mask:0xf
    v_mov_b32_dpp v53, v20 quad_perm:[0,0,0,0] row_mask:0xf bank_mask:0xf
    s_nop 0
    v_add_f32_dpp v52, v17, v52 quad_perm:[1,1,1,1] row_mask:0xf bank_mask:0xf
    v_add_f32_dpp v53, v21, v53 quad_perm:[1,1,1,1] row_mask:0xf bank_mask:0xf
    v_mfma_f32_16x16x32_bf16 v[24:27], a[104:107], v[40:43], v[24:27]
    v_add_f32_dpp v52, v18, v52 quad_perm:[2,2,2,2] row_mask:0xf bank_mask:0xf
    v_add_f32_dpp v53, v22, v53 quad_perm:[2,2,2,2] row_mask:0xf bank_mask:0xf
    s_nop 0
    v_add_f32_dpp v52, v19, v52 quad_perm:[3,3,3,3] row_mask:0xf bank_mask:0xf
    v_add_f32_dpp v53, v23, v53 quad_perm:[3,3,3,3] row_mask:0xf bank_mask:0xf
    v_mfma_f32_16x16x32_bf16 v[28:31], a[120:123], v[40:43], v[28:31]
    v_cvt_pk_bf16_f32 v56, v52, v53
    v_lshlrev_b32 v52, 16, v56
    v_and_b32 v53, 0xffff0000, v56
    v_mul_f32 v52, 0x3db504f3, v52
    v_mfma_f32_16x16x32_bf16 v[24:27], a[108:111], v[60:63], v[24:27]
    v_mul_f32 v53, 0x3db504f3, v53
    v_cvt_pk_bf16_f32 v56, v52, v53
    v_lshlrev_b32 v52, 16, v56
    v_and_b32 v53, 0xffff0000, v56
    v_mfma_f32_16x16x32_bf16 v[28:31], a[124:127], v[60:63], v[28:31]
    buffer_load_dwordx4 a[0:3], v13, s[48:51], s3 offen nt
    s_addk_i32 s3, 4096
    s_bitset0_b32 s3, 17
    v_mov_b32_dpp v54, v24 quad_perm:[0,0,0,0] row_mask:0xf bank_mask:0xf
    s_nop 3
    v_mov_b32_dpp v55, v28 quad_perm:[0,0,0,0] row_mask:0xf bank_mask:0xf
    v_add_f32_dpp v54, v25, v54 quad_perm:[1,1,1,1] row_mask:0xf bank_mask:0xf
    s_nop 0
    v_add_f32_dpp v55, v29, v55 quad_perm:[1,1,1,1] row_mask:0xf bank_mask:0xf
    v_add_f32_dpp v54, v26, v54 quad_perm:[2,2,2,2] row_mask:0xf bank_mask:0xf
    s_nop 0
    v_add_f32_dpp v55, v30, v55 quad_perm:[2,2,2,2] row_mask:0xf bank_mask:0xf
    v_add_f32_dpp v54, v27, v54 quad_perm:[3,3,3,3] row_mask:0xf bank_mask:0xf
    s_nop 0
    v_add_f32_dpp v55, v31, v55 quad_perm:[3,3,3,3] row_mask:0xf bank_mask:0xf
    v_cvt_pk_bf16_f32 v56, v54, v55
    v_lshlrev_b32 v54, 16, v56
    v_and_b32 v55, 0xffff0000, v56
    v_mul_f32 v54, 0x3db504f3, v54
    v_mul_f32 v55, 0x3db504f3, v55
    v_cvt_pk_bf16_f32 v56, v54, v55
    v_lshlrev_b32 v54, 16, v56
    v_and_b32 v55, 0xffff0000, v56
    buffer_load_dwordx4 a[4:7], v13, s[48:51], s3 offen nt
    s_addk_i32 s3, 4096
    s_bitset0_b32 s3, 17
    v_max3_f32 v16, v48, v49, v50
    v_max3_f32 v17, v51, v52, v53
    v_max3_f32 v16, v16, v54, v55
    v_max_f32 v16, v16, v17
    s_nop 1
    v_max_f32_dpp v16, v16, v16 row_ror:8 row_mask:0xf bank_mask:0xf
    s_nop 1
    v_max_f32_dpp v16, v16, v16 row_ror:4 row_mask:0xf bank_mask:0xf
    s_nop 1
    v_max_f32_dpp v16, v16, v16 row_bcast:15 row_mask:0xa bank_mask:0xf
    s_nop 1
    v_max_f32_dpp v16, v16, v16 row_bcast:31 row_mask:0xc bank_mask:0xf
    s_mov_b32 s74, 0x3fb8aa3b
    v_readlane_b32 s35, v16, 63
    s_nop 1
    v_subrev_f32 v48, s35, v48
    v_subrev_f32 v49, s35, v49
    v_subrev_f32 v50, s35, v50
    v_subrev_f32 v51, s35, v51
    v_subrev_f32 v52, s35, v52
    v_subrev_f32 v53, s35, v53
    v_subrev_f32 v54, s35, v54
    v_subrev_f32 v55, s35, v55
    v_mul_f32 v48, s74, v48
    v_mul_f32 v49, s74, v49
    v_mul_f32 v50, s74, v50
    v_mul_f32 v51, s74, v51
    v_mul_f32 v52, s74, v52
    v_mul_f32 v53, s74, v53
    v_mul_f32 v54, s74, v54
    v_mul_f32 v55, s74, v55
    v_exp_f32 v48, v48
    v_exp_f32 v49, v49
    v_exp_f32 v50, v50
    v_exp_f32 v51, v51
    v_exp_f32 v52, v52
    v_exp_f32 v53, v53
    v_exp_f32 v54, v54
    v_exp_f32 v55, v55
    v_add_f32 v18, v48, v49
    v_add_f32 v19, v50, v51
    v_add_f32 v20, v52, v53
    v_add_f32 v21, v54, v55
    v_add_f32 v18, v18, v19
    v_add_f32 v20, v20, v21
    v_add_f32 v17, v18, v20
    buffer_load_dwordx4 a[8:11], v13, s[48:51], s3 offen nt
    s_addk_i32 s3, 4096
    s_bitset0_b32 s3, 17
    v_cvt_pk_bf16_f32 v48, v48, v48
    v_cvt_pk_bf16_f32 v49, v49, v49
    v_cvt_pk_bf16_f32 v50, v50, v50
    v_cvt_pk_bf16_f32 v51, v51, v51
    v_cvt_pk_bf16_f32 v52, v52, v52
    v_cvt_pk_bf16_f32 v53, v53, v53
    v_cvt_pk_bf16_f32 v54, v54, v54
    v_cvt_pk_bf16_f32 v55, v55, v55
    v_add_f32_dpp v17, v17, v17 row_ror:8 row_mask:0xf bank_mask:0xf
    s_nop 1
    v_add_f32_dpp v17, v17, v17 row_ror:4 row_mask:0xf bank_mask:0xf
    s_nop 1
    v_add_f32_dpp v17, v17, v17 row_bcast:15 row_mask:0xa bank_mask:0xf
    s_nop 1
    v_add_f32_dpp v17, v17, v17 row_bcast:31 row_mask:0xc bank_mask:0xf
    s_lshl_b32 s35, s34, 3
    v_mov_b32 v18, s35
    s_mov_b32 exec_lo, 0
    s_brev_b32 exec_hi, 1
    ds_write_b64 v18, v[16:17] offset:8192
    s_mov_b64 exec, -1
    s_lshl_b32 s35, s32, 13
    s_add_u32 s35, s35, 327680
    v_add_u32 v45, s35, v47
    v_lshrrev_b32 v44, 3, v2
    v_and_b32 v29, 3, v2
    v_lshl_add_u32 v44, v44, 2, v29
    s_add_u32 s75, s35, 0x1000
    v_lshl_add_u32 v44, v44, 4, s75
    s_cmp_eq_u32 s64, 1
    s_cbranch_scc1 L_noha_do
L_noha:
    s_lshl4_add_u32 s75, s33, s75
    s_and_b32 s79, s33, 4
    s_add_u32 s79, s79, s33
    s_lshl4_add_u32 s35, s79, s35
    v_lshrrev_b32 v46, 1, v0
    v_and_b32 v29, 1, v0
    v_lshl_add_u32 v46, v46, 2, v29
    v_lshl_add_u32 v46, v46, 6, s35
    s_lshl_b32 s35, s65, 17
    s_add_u32 s35, s35, 1048576
    s_and_b32 s79, s65, 4
    s_xor_b32 s79, s79, 4
    s_lshl_b32 s79, s79, 12
    s_add_u32 s35, s35, s79
    s_lshr_b32 s79, s32, 3
    s_lshl_b32 s79, s79, 15
    s_add_u32 s35, s35, s79
    s_and_b32 s79, s32, 7
    s_lshl_b32 s79, s79, 10
    s_add_u32 s35, s35, s79
    s_and_b32 s79, s32, 14
    s_lshl_b32 s79, s79, 6
    s_add_u32 s35, s35, s79
    v_xor_b32 v3, s35, v15
    s_lshl_b32 s35, s32, 3
    s_add_u32 s35, s35, s65
    s_lshl_b32 s35, s35, 10
    s_add_u32 s35, s35, 655360
    v_add_u32 v39, s35, v15
    s_mov_b64 s[20:21], s[28:29]
    s_mov_b32 s23, 0x20000
    s_cmp_lt_u32 s40, 27
    s_cselect_b32 s22, 0x200000, 0
    s_cselect_b64 s[24:25], s[60:61], 0
    s_cselect_b64 s[26:27], s[62:63], 0
    s_cmp_eq_u32 s34, 0
    s_cselect_b32 s22, s22, 0
    v_lshrrev_b32 v38, 5, v0
    v_lshlrev_b32 v38, 3, v38
    v_add_u32 v38, 622592, v38
    s_and_b32 s41, s38, -2
    v_and_b32_dpp v56, v48, v4 row_newbcast:0 row_mask:0xf bank_mask:0xf
    v_and_b32_dpp v57, v48, v5 row_newbcast:0 row_mask:0xf bank_mask:0xf
    v_and_b32_dpp v58, v48, v6 row_newbcast:0 row_mask:0xf bank_mask:0xf
    v_and_b32_dpp v59, v48, v7 row_newbcast:0 row_mask:0xf bank_mask:0xf
    s_waitcnt vmcnt(18)
    s_nop 0
    v_mfma_f32_16x16x32_bf16 v[32:35], v[56:59], v[64:67], 0
    v_and_b32_dpp v60, v48, v4 row_newbcast:4 row_mask:0xf bank_mask:0xf
    v_and_b32_dpp v61, v48, v5 row_newbcast:4 row_mask:0xf bank_mask:0xf
    v_and_b32_dpp v62, v48, v6 row_newbcast:4 row_mask:0xf bank_mask:0xf
    v_and_b32_dpp v63, v48, v7 row_newbcast:4 row_mask:0xf bank_mask:0xf
    s_waitcnt vmcnt(17)
    s_nop 0
    v_mfma_f32_16x16x32_bf16 v[32:35], v[60:63], v[68:71], v[32:35]
    v_and_b32_dpp v56, v48, v4 row_newbcast:8 row_mask:0xf bank_mask:0xf
    v_and_b32_dpp v57, v48, v5 row_newbcast:8 row_mask:0xf bank_mask:0xf
    v_and_b32_dpp v58, v48, v6 row_newbcast:8 row_mask:0xf bank_mask:0xf
    v_and_b32_dpp v59, v48, v7 row_newbcast:8 row_mask:0xf bank_mask:0xf
    s_waitcnt vmcnt(16)
    s_nop 0
    v_mfma_f32_16x16x32_bf16 v[32:35], v[56:59], v[72:75], v[32:35]
    v_and_b32_dpp v60, v48, v4 row_newbcast:12 row_mask:0xf bank_mask:0xf
    v_and_b32_dpp v61, v48, v5 row_newbcast:12 row_mask:0xf bank_mask:0xf
    v_and_b32_dpp v62, v48, v6 row_newbcast:12 row_mask:0xf bank_mask:0xf
    v_and_b32_dpp v63, v48, v7 row_newbcast:12 row_mask:0xf bank_mask:0xf
    buffer_load_dwordx4 a[12:15], v13, s[48:51], s3 offen nt
    s_addk_i32 s3, 4096
    s_bitset0_b32 s3, 17
    s_waitcnt vmcnt(16)
    v_mfma_f32_16x16x32_bf16 v[32:35], v[60:63], v[76:79], v[32:35]
    v_and_b32_dpp v56, v49, v4 row_newbcast:0 row_mask:0xf bank_mask:0xf
    v_and_b32_dpp v57, v49, v5 row_newbcast:0 row_mask:0xf bank_mask:0xf
    v_and_b32_dpp v58, v49, v6 row_newbcast:0 row_mask:0xf bank_mask:0xf
    v_and_b32_dpp v59, v49, v7 row_newbcast:0 row_mask:0xf bank_mask:0xf
    buffer_load_dwordx4 a[16:19], v13, s[48:51], s3 offen nt
    s_addk_i32 s3, 4096
    s_bitset0_b32 s3, 17
    s_cmp_lg_u32 s34, 0
    s_cbranch_scc0 L_noml_do
L_noml:
    s_waitcnt vmcnt(16)
    v_mfma_f32_16x16x32_bf16 v[32:35], v[56:59], v[80:83], v[32:35]
    v_and_b32_dpp v60, v49, v4 row_newbcast:4 row_mask:0xf bank_mask:0xf
    v_and_b32_dpp v61, v49, v5 row_newbcast:4 row_mask:0xf bank_mask:0xf
    v_and_b32_dpp v62, v49, v6 row_newbcast:4 row_mask:0xf bank_mask:0xf
    v_and_b32_dpp v63, v49, v7 row_newbcast:4 row_mask:0xf bank_mask:0xf
    buffer_load_dwordx4 a[20:23], v13, s[48:51], s3 offen nt
    s_addk_i32 s3, 4096
    s_bitset0_b32 s3, 17
    s_waitcnt vmcnt(16)
    v_mfma_f32_16x16x32_bf16 v[32:35], v[60:63], v[84:87], v[32:35]
    v_and_b32_dpp v56, v49, v4 row_newbcast:8 row_mask:0xf bank_mask:0xf
    v_and_b32_dpp v57, v49, v5 row_newbcast:8 row_mask:0xf bank_mask:0xf
    v_and_b32_dpp v58, v49, v6 row_newbcast:8 row_mask:0xf bank_mask:0xf
    v_and_b32_dpp v59, v49, v7 row_newbcast:8 row_mask:0xf bank_mask:0xf
    buffer_load_dwordx4 a[24:27], v13, s[48:51], s3 offen nt
    s_addk_i32 s3, 4096
    s_bitset0_b32 s3, 17
    s_waitcnt vmcnt(16)
    v_mfma_f32_16x16x32_bf16 v[32:35], v[56:59], v[88:91], v[32:35]
    v_and_b32_dpp v60, v49, v4 row_newbcast:12 row_mask:0xf bank_mask:0xf
    v_and_b32_dpp v61, v49, v5 row_newbcast:12 row_mask:0xf bank_mask:0xf
    v_and_b32_dpp v62, v49, v6 row_newbcast:12 row_mask:0xf bank_mask:0xf
    v_and_b32_dpp v63, v49, v7 row_newbcast:12 row_mask:0xf bank_mask:0xf
    buffer_load_dwordx4 a[28:31], v13, s[48:51], s3 offen nt
    s_addk_i32 s3, 4096
    s_bitset0_b32 s3, 17
    s_waitcnt vmcnt(16)
    v_mfma_f32_16x16x32_bf16 v[32:35], v[60:63], v[92:95], v[32:35]
    v_and_b32_dpp v56, v50, v4 row_newbcast:0 row_mask:0xf bank_mask:0xf
    v_and_b32_dpp v57, v50, v5 row_newbcast:0 row_mask:0xf bank_mask:0xf
    v_and_b32_dpp v58, v50, v6 row_newbcast:0 row_mask:0xf bank_mask:0xf
    v_and_b32_dpp v59, v50, v7 row_newbcast:0 row_mask:0xf bank_mask:0xf
    buffer_load_dwordx4 a[32:35], v13, s[48:51], s3 offen nt
    s_addk_i32 s3, 4096
    s_bitset0_b32 s3, 17
    s_waitcnt vmcnt(16)
    v_mfma_f32_16x16x32_bf16 v[32:35], v[56:59], v[96:99], v[32:35]
    v_and_b32_dpp v60, v50, v4 row_newbcast:4 row_mask:0xf bank_mask:0xf
    v_and_b32_dpp v61, v50, v5 row_newbcast:4 row_mask:0xf bank_mask:0xf
    v_and_b32_dpp v62, v50, v6 row_newbcast:4 row_mask:0xf bank_mask:0xf
    v_and_b32_dpp v63, v50, v7 row_newbcast:4 row_mask:0xf bank_mask:0xf
    buffer_load_dwordx4 a[36:39], v13, s[48:51], s3 offen nt
    s_addk_i32 s3, 4096
    s_bitset0_b32 s3, 17
    s_waitcnt vmcnt(16)
    v_mfma_f32_16x16x32_bf16 v[32:35], v[60:63], v[100:103], v[32:35]
    v_and_b32_dpp v56, v50, v4 row_newbcast:8 row_mask:0xf bank_mask:0xf
    v_and_b32_dpp v57, v50, v5 row_newbcast:8 row_mask:0xf bank_mask:0xf
    v_and_b32_dpp v58, v50, v6 row_newbcast:8 row_mask:0xf bank_mask:0xf
    v_and_b32_dpp v59, v50, v7 row_newbcast:8 row_mask:0xf bank_mask:0xf
    buffer_load_dwordx4 a[40:43], v13, s[48:51], s3 offen nt
    s_addk_i32 s3, 4096
    s_bitset0_b32 s3, 17
    s_waitcnt vmcnt(16)
    v_mfma_f32_16x16x32_bf16 v[32:35], v[56:59], v[104:107], v[32:35]
    v_and_b32_dpp v60, v50, v4 row_newbcast:12 row_mask:0xf bank_mask:0xf
    v_and_b32_dpp v61, v50, v5 row_newbcast:12 row_mask:0xf bank_mask:0xf
    v_and_b32_dpp v62, v50, v6 row_newbcast:12 row_mask:0xf bank_mask:0xf
    v_and_b32_dpp v63, v50, v7 row_newbcast:12 row_mask:0xf bank_mask:0xf
    buffer_load_dwordx4 a[44:47], v13, s[48:51], s3 offen nt
    s_addk_i32 s3, 4096
    s_bitset0_b32 s3, 17
    s_waitcnt vmcnt(16)
    v_mfma_f32_16x16x32_bf16 v[32:35], v[60:63], v[108:111], v[32:35]
    v_and_b32_dpp v56, v51, v4 row_newbcast:0 row_mask:0xf bank_mask:0xf
    v_and_b32_dpp v57, v51, v5 row_newbcast:0 row_mask:0xf bank_mask:0xf
    v_and_b32_dpp v58, v51, v6 row_newbcast:0 row_mask:0xf bank_mask:0xf
    v_and_b32_dpp v59, v51, v7 row_newbcast:0 row_mask:0xf bank_mask:0xf
    buffer_load_dwordx4 a[48:51], v13, s[48:51], s3 offen nt
    s_addk_i32 s3, 4096
    s_bitset0_b32 s3, 17
    s_waitcnt vmcnt(16)
    v_mfma_f32_16x16x32_bf16 v[32:35], v[56:59], v[112:115], v[32:35]
    v_and_b32_dpp v60, v51, v4 row_newbcast:4 row_mask:0xf bank_mask:0xf
    v_and_b32_dpp v61, v51, v5 row_newbcast:4 row_mask:0xf bank_mask:0xf
    v_and_b32_dpp v62, v51, v6 row_newbcast:4 row_mask:0xf bank_mask:0xf
    v_and_b32_dpp v63, v51, v7 row_newbcast:4 row_mask:0xf bank_mask:0xf
    buffer_load_dwordx4 a[52:55], v13, s[48:51], s3 offen nt
    s_addk_i32 s3, 4096
    s_bitset0_b32 s3, 17
    s_waitcnt vmcnt(16)
    v_mfma_f32_16x16x32_bf16 v[32:35], v[60:63], v[116:119], v[32:35]
    v_and_b32_dpp v56, v51, v4 row_newbcast:8 row_mask:0xf bank_mask:0xf
    v_and_b32_dpp v57, v51, v5 row_newbcast:8 row_mask:0xf bank_mask:0xf
    v_and_b32_dpp v58, v51, v6 row_newbcast:8 row_mask:0xf bank_mask:0xf
    v_and_b32_dpp v59, v51, v7 row_newbcast:8 row_mask:0xf bank_mask:0xf
    buffer_load_dwordx4 a[56:59], v13, s[48:51], s3 offen nt
    s_addk_i32 s3, 4096
    s_bitset0_b32 s3, 17
    s_waitcnt vmcnt(16)
    v_mfma_f32_16x16x32_bf16 v[32:35], v[56:59], v[120:123], v[32:35]
    v_and_b32_dpp v60, v51, v4 row_newbcast:12 row_mask:0xf bank_mask:0xf
    v_and_b32_dpp v61, v51, v5 row_newbcast:12 row_mask:0xf bank_mask:0xf
    v_and_b32_dpp v62, v51, v6 row_newbcast:12 row_mask:0xf bank_mask:0xf
    v_and_b32_dpp v63, v51, v7 row_newbcast:12 row_mask:0xf bank_mask:0xf
    buffer_load_dwordx4 a[60:63], v13, s[48:51], s3 offen nt
    s_addk_i32 s3, 4096
    s_bitset0_b32 s3, 17
    s_waitcnt vmcnt(16)
    v_mfma_f32_16x16x32_bf16 v[32:35], v[60:63], v[124:127], v[32:35]
    v_and_b32_dpp v56, v52, v4 row_newbcast:0 row_mask:0xf bank_mask:0xf
    v_and_b32_dpp v57, v52, v5 row_newbcast:0 row_mask:0xf bank_mask:0xf
    v_and_b32_dpp v58, v52, v6 row_newbcast:0 row_mask:0xf bank_mask:0xf
    v_and_b32_dpp v59, v52, v7 row_newbcast:0 row_mask:0xf bank_mask:0xf
    s_barrier
    buffer_load_dword v28, v39, s[20:23], 0 offen sc1
    global_load_dword v28, v45, s[28:29] sc1
    global_load_dwordx2 v[36:37], v38, s[28:29]
    global_load_dwordx4 v[28:31], v44, s[28:29]
    s_waitcnt vmcnt(19)
    v_mfma_f32_16x16x32_bf16 v[32:35], v[56:59], a[0:3], v[32:35]
    v_and_b32_dpp v60, v52, v4 row_newbcast:4 row_mask:0xf bank_mask:0xf
    v_and_b32_dpp v61, v52, v5 row_newbcast:4 row_mask:0xf bank_mask:0xf
    v_and_b32_dpp v62, v52, v6 row_newbcast:4 row_mask:0xf bank_mask:0xf
    v_and_b32_dpp v63, v52, v7 row_newbcast:4 row_mask:0xf bank_mask:0xf
    buffer_load_dwordx4 a[64:67], v14, s[52:55], s66 offen offset:0 nt
    s_waitcnt vmcnt(19)
    v_mfma_f32_16x16x32_bf16 v[32:35], v[60:63], a[4:7], v[32:35]
    v_and_b32_dpp v56, v52, v4 row_newbcast:8 row_mask:0xf bank_mask:0xf
    v_and_b32_dpp v57, v52, v5 row_newbcast:8 row_mask:0xf bank_mask:0xf
    v_and_b32_dpp v58, v52, v6 row_newbcast:8 row_mask:0xf bank_mask:0xf
    v_and_b32_dpp v59, v52, v7 row_newbcast:8 row_mask:0xf bank_mask:0xf
    buffer_load_dwordx4 a[68:71], v14, s[52:55], s66 offen offset:1280 nt
    s_waitcnt vmcnt(19)
    v_mfma_f32_16x16x32_bf16 v[32:35], v[56:59], a[8:11], v[32:35]
    v_and_b32_dpp v60, v52, v4 row_newbcast:12 row_mask:0xf bank_mask:0xf
    v_and_b32_dpp v61, v52, v5 row_newbcast:12 row_mask:0xf bank_mask:0xf
    v_and_b32_dpp v62, v52, v6 row_newbcast:12 row_mask:0xf bank_mask:0xf
    v_and_b32_dpp v63, v52, v7 row_newbcast:12 row_mask:0xf bank_mask:0xf
    buffer_load_dwordx4 a[72:75], v14, s[52:55], s66 offen offset:2560 nt
    s_waitcnt vmcnt(19)
    v_mfma_f32_16x16x32_bf16 v[32:35], v[60:63], a[12:15], v[32:35]
    v_and_b32_dpp v56, v53, v4 row_newbcast:0 row_mask:0xf bank_mask:0xf
    v_and_b32_dpp v57, v53, v5 row_newbcast:0 row_mask:0xf bank_mask:0xf
    v_and_b32_dpp v58, v53, v6 row_newbcast:0 row_mask:0xf bank_mask:0xf
    v_and_b32_dpp v59, v53, v7 row_newbcast:0 row_mask:0xf bank_mask:0xf
    s_waitcnt vmcnt(18)
    s_nop 0
    v_mfma_f32_16x16x32_bf16 v[32:35], v[56:59], a[16:19], v[32:35]
    v_and_b32_dpp v60, v53, v4 row_newbcast:4 row_mask:0xf bank_mask:0xf
    v_and_b32_dpp v61, v53, v5 row_newbcast:4 row_mask:0xf bank_mask:0xf
    v_and_b32_dpp v62, v53, v6 row_newbcast:4 row_mask:0xf bank_mask:0xf
    v_and_b32_dpp v63, v53, v7 row_newbcast:4 row_mask:0xf bank_mask:0xf
    s_waitcnt vmcnt(17)
    s_nop 0
    v_mfma_f32_16x16x32_bf16 v[32:35], v[60:63], a[20:23], v[32:35]
    v_and_b32_dpp v56, v53, v4 row_newbcast:8 row_mask:0xf bank_mask:0xf
    v_and_b32_dpp v57, v53, v5 row_newbcast:8 row_mask:0xf bank_mask:0xf
    v_and_b32_dpp v58, v53, v6 row_newbcast:8 row_mask:0xf bank_mask:0xf
    v_and_b32_dpp v59, v53, v7 row_newbcast:8 row_mask:0xf bank_mask:0xf
    s_waitcnt vmcnt(16)
    s_nop 0
    v_mfma_f32_16x16x32_bf16 v[32:35], v[56:59], a[24:27], v[32:35]
    v_and_b32_dpp v60, v53, v4 row_newbcast:12 row_mask:0xf bank_mask:0xf
    v_and_b32_dpp v61, v53, v5 row_newbcast:12 row_mask:0xf bank_mask:0xf
    v_and_b32_dpp v62, v53, v6 row_newbcast:12 row_mask:0xf bank_mask:0xf
    v_and_b32_dpp v63, v53, v7 row_newbcast:12 row_mask:0xf bank_mask:0xf
    s_waitcnt vmcnt(15)
    s_nop 0
    v_mfma_f32_16x16x32_bf16 v[32:35], v[60:63], a[28:31], v[32:35]
    v_and_b32_dpp v64, v54, v4 row_newbcast:0 row_mask:0xf bank_mask:0xf
    v_and_b32_dpp v65, v54, v5 row_newbcast:0 row_mask:0xf bank_mask:0xf
    v_and_b32_dpp v66, v54, v6 row_newbcast:0 row_mask:0xf bank_mask:0xf
    v_and_b32_dpp v67, v54, v7 row_newbcast:0 row_mask:0xf bank_mask:0xf
    v_and_b32_dpp v68, v54, v4 row_newbcast:4 row_mask:0xf bank_mask:0xf
    v_and_b32_dpp v69, v54, v5 row_newbcast:4 row_mask:0xf bank_mask:0xf
    v_and_b32_dpp v70, v54, v6 row_newbcast:4 row_mask:0xf bank_mask:0xf
    v_and_b32_dpp v71, v54, v7 row_newbcast:4 row_mask:0xf bank_mask:0xf
    v_and_b32_dpp v72, v54, v4 row_newbcast:8 row_mask:0xf bank_mask:0xf
    v_and_b32_dpp v73, v54, v5 row_newbcast:8 row_mask:0xf bank_mask:0xf
    v_and_b32_dpp v74, v54, v6 row_newbcast:8 row_mask:0xf bank_mask:0xf
    v_and_b32_dpp v75, v54, v7 row_newbcast:8 row_mask:0xf bank_mask:0xf
    v_and_b32_dpp v76, v54, v4 row_newbcast:12 row_mask:0xf bank_mask:0xf
    v_and_b32_dpp v77, v54, v5 row_newbcast:12 row_mask:0xf bank_mask:0xf
    v_and_b32_dpp v78, v54, v6 row_newbcast:12 row_mask:0xf bank_mask:0xf
    v_and_b32_dpp v79, v54, v7 row_newbcast:12 row_mask:0xf bank_mask:0xf
    v_and_b32_dpp v80, v55, v4 row_newbcast:0 row_mask:0xf bank_mask:0xf
    v_and_b32_dpp v81, v55, v5 row_newbcast:0 row_mask:0xf bank_mask:0xf
    v_and_b32_dpp v82, v55, v6 row_newbcast:0 row_mask:0xf bank_mask:0xf
    v_and_b32_dpp v83, v55, v7 row_newbcast:0 row_mask:0xf bank_mask:0xf
    v_and_b32_dpp v84, v55, v4 row_newbcast:4 row_mask:0xf bank_mask:0xf
    v_and_b32_dpp v85, v55, v5 row_newbcast:4 row_mask:0xf bank_mask:0xf
    v_and_b32_dpp v86, v55, v6 row_newbcast:4 row_mask:0xf bank_mask:0xf
    v_and_b32_dpp v87, v55, v7 row_newbcast:4 row_mask:0xf bank_mask:0xf
    v_and_b32_dpp v88, v55, v4 row_newbcast:8 row_mask:0xf bank_mask:0xf
    v_and_b32_dpp v89, v55, v5 row_newbcast:8 row_mask:0xf bank_mask:0xf
    v_and_b32_dpp v90, v55, v6 row_newbcast:8 row_mask:0xf bank_mask:0xf
    v_and_b32_dpp v91, v55, v7 row_newbcast:8 row_mask:0xf bank_mask:0xf
    v_and_b32_dpp v92, v55, v4 row_newbcast:12 row_mask:0xf bank_mask:0xf
    v_and_b32_dpp v93, v55, v5 row_newbcast:12 row_mask:0xf bank_mask:0xf
    v_and_b32_dpp v94, v55, v6 row_newbcast:12 row_mask:0xf bank_mask:0xf
    v_and_b32_dpp v95, v55, v7 row_newbcast:12 row_mask:0xf bank_mask:0xf
    s_waitcnt vmcnt(14)
    v_mfma_f32_16x16x32_bf16 v[32:35], v[64:67], a[32:35], v[32:35]
    s_waitcnt vmcnt(13)
    v_mfma_f32_16x16x32_bf16 v[32:35], v[68:71], a[36:39], v[32:35]
    s_waitcnt vmcnt(12)
    v_mfma_f32_16x16x32_bf16 v[32:35], v[72:75], a[40:43], v[32:35]
    s_waitcnt vmcnt(11)
    v_mfma_f32_16x16x32_bf16 v[32:35], v[76:79], a[44:47], v[32:35]
    s_waitcnt vmcnt(10)
    v_mfma_f32_16x16x32_bf16 v[32:35], v[80:83], a[48:51], v[32:35]
    s_waitcnt vmcnt(9)
    v_mfma_f32_16x16x32_bf16 v[32:35], v[84:87], a[52:55], v[32:35]
    s_waitcnt vmcnt(8)
    v_mfma_f32_16x16x32_bf16 v[32:35], v[88:91], a[56:59], v[32:35]
    s_waitcnt vmcnt(7)
    v_mfma_f32_16x16x32_bf16 v[32:35], v[92:95], a[60:63], v[32:35]
    s_cmp_lg_u32 s34, 0
    s_mov_b32 exec_hi, 0
    s_nop 5
    ds_write_b128 v47, v[32:35]
    s_waitcnt lgkmcnt(0)
    s_barrier
    s_cbranch_scc1 L_opubnear
    ds_read_b128 v[16:19], v47 offset:1024
    ds_read_b128 v[20:23], v47 offset:2048
    ds_read_b128 v[24:27], v47 offset:3072
    v_pk_mul_f32 v[32:33], v[40:41], v[32:33] op_sel:[0,0] op_sel_hi:[0,1]
    v_pk_mul_f32 v[34:35], v[40:41], v[34:35] op_sel:[0,0] op_sel_hi:[0,1]
    s_bitcmp1_b32 s31, 0
    s_waitcnt lgkmcnt(2)
    v_pk_fma_f32 v[32:33], v[40:41], v[16:17], v[32:33] op_sel:[1,0,0] op_sel_hi:[1,1,1]
    v_pk_fma_f32 v[34:35], v[40:41], v[18:19], v[34:35] op_sel:[1,0,0] op_sel_hi:[1,1,1]
    s_waitcnt lgkmcnt(1)
    v_pk_fma_f32 v[32:33], v[42:43], v[20:21], v[32:33] op_sel:[0,0,0] op_sel_hi:[0,1,1]
    v_pk_fma_f32 v[34:35], v[42:43], v[22:23], v[34:35] op_sel:[0,0,0] op_sel_hi:[0,1,1]
    s_waitcnt lgkmcnt(0)
    v_pk_fma_f32 v[32:33], v[42:43], v[24:25], v[32:33] op_sel:[1,0,0] op_sel_hi:[1,1,1]
    v_pk_fma_f32 v[34:35], v[42:43], v[26:27], v[34:35] op_sel:[1,0,0] op_sel_hi:[1,1,1]
    v_and_or_b32 v32, v32, s76, v8
    v_and_or_b32 v33, v33, s76, v9
    v_and_or_b32 v34, v34, s76, v10
    v_and_or_b32 v35, v35, s76, v11
    s_cbranch_scc1 L_opubfar
    global_store_dwordx4 v46, v[32:35], s[28:29]
L_opubnear:
    s_barrier
    s_mov_b32 exec_hi, -1
    buffer_load_dwordx4 a[76:79], v14, s[52:55], s66 offen offset:3840 nt
    buffer_load_dwordx4 a[80:83], v14, s[52:55], s67 offen offset:0 nt
    buffer_load_dwordx4 a[84:87], v14, s[52:55], s67 offen offset:1280 nt
    buffer_load_dwordx4 a[88:91], v14, s[52:55], s67 offen offset:2560 nt
    buffer_load_dwordx4 a[92:95], v14, s[52:55], s67 offen offset:3840 nt
    s_cmp_eq_u32 s64, 0
    s_cbranch_scc0 L_notwo
    s_waitcnt vmcnt(8)
L_mchk:
    v_xor_b32 v29, s36, v29
    v_xor_b32 v31, s37, v31
    v_or_b32 v29, v29, v31
    v_cmp_ne_u32 vcc, 0, v29
    s_cbranch_vccnz L_mretry
    v_max_f32_dpp v29, v28, v28 quad_perm:[1,0,3,2] row_mask:0xf bank_mask:0xf
    s_nop 1
    v_max_f32_dpp v29, v29, v29 quad_perm:[2,3,0,1] row_mask:0xf bank_mask:0xf
    v_sub_f32 v28, v28, v29
    v_mul_f32 v28, s74, v28
    v_exp_f32 v28, v28
    s_nop 0
    v_mul_f32 v30, v30, v28
    s_nop 1
    v_add_f32_dpp v30, v30, v30 quad_perm:[1,0,3,2] row_mask:0xf bank_mask:0xf
    s_nop 1
    v_add_f32_dpp v30, v30, v30 quad_perm:[2,3,0,1] row_mask:0xf bank_mask:0xf
    v_rcp_f32 v30, v30
    s_nop 0
    v_mul_f32 v28, v28, v30
L_gachk:
    v_xor_b32 v37, s41, v37
    v_cmp_lt_u32 vcc, 1, v37
    s_cbranch_vccnz L_garetry
    v_lshlrev_b32 v36, 16, v36
    v_lshlrev_b32 v37, 13, v37
    v_xor_b32 v3, v3, v37
    s_waitcnt vmcnt(5)
L_oloop:
    global_load_dwordx4 v[16:19], v45, s[28:29] sc1
    s_sub_u32 s77, s77, 1
    s_cbranch_scc1 L_exit
    s_waitcnt vmcnt(0)
    v_xor_b32 v16, s60, v16
    v_xor_b32 v17, s61, v17
    v_xor_b32 v18, s62, v18
    v_xor_b32_e64 v19, s63, v19
    v_or3_b32 v20, v16, v17, v18
    v_bitop3_b32 v20, v20, v19, s76 bitop3:0x54
    v_cmp_ne_u32 vcc, 0, v20
    v_pk_mul_f32 v[16:17], v[28:29], v[16:17] op_sel:[0,0] op_sel_hi:[0,1]
    v_pk_mul_f32 v[18:19], v[28:29], v[18:19] op_sel:[0,0] op_sel_hi:[0,1]
    s_cbranch_vccnz L_oloop
    v_add_f32_dpp v16, v16, v16 quad_perm:[1,0,3,2] row_mask:0xf bank_mask:0xf
    v_add_f32_dpp v17, v17, v17 quad_perm:[1,0,3,2] row_mask:0xf bank_mask:0xf
    v_add_f32_dpp v18, v18, v18 quad_perm:[1,0,3,2] row_mask:0xf bank_mask:0xf
    v_add_f32_dpp v19, v19, v19 quad_perm:[1,0,3,2] row_mask:0xf bank_mask:0xf
    v_add_f32_dpp v16, v16, v16 quad_perm:[2,3,0,1] row_mask:0xf bank_mask:0xf
    v_add_f32_dpp v17, v17, v17 quad_perm:[2,3,0,1] row_mask:0xf bank_mask:0xf
    v_add_f32_dpp v18, v18, v18 quad_perm:[2,3,0,1] row_mask:0xf bank_mask:0xf
    v_add_f32_dpp v19, v19, v19 quad_perm:[2,3,0,1] row_mask:0xf bank_mask:0xf
    v_cvt_pk_bf16_f32 v48, v16, v16
    v_cvt_pk_bf16_f32 v49, v17, v17
    v_cvt_pk_bf16_f32 v50, v18, v18
    v_cvt_pk_bf16_f32 v51, v19, v19
    v_and_b32 v64, v48, v4
    v_and_b32 v65, v48, v5
    v_and_b32_dpp v66, v48, v6 row_half_mirror row_mask:0xf bank_mask:0xf
    v_and_b32_dpp v67, v48, v7 row_half_mirror row_mask:0xf bank_mask:0xf
    buffer_load_dwordx4 v[52:55], v39, s[20:23], 0 offen sc1
    v_and_b32 v68, v49, v4
    v_and_b32 v69, v49, v5
    v_and_b32_dpp v70, v49, v6 row_half_mirror row_mask:0xf bank_mask:0xf
    v_and_b32_dpp v71, v49, v7 row_half_mirror row_mask:0xf bank_mask:0xf
    v_mfma_f32_16x16x32_bf16 v[32:35], v[64:67], a[64:67], 0
    v_and_b32 v72, v50, v4
    v_and_b32 v73, v50, v5
    v_and_b32_dpp v74, v50, v6 row_half_mirror row_mask:0xf bank_mask:0xf
    v_and_b32_dpp v75, v50, v7 row_half_mirror row_mask:0xf bank_mask:0xf
    v_mfma_f32_16x16x32_bf16 v[32:35], v[68:71], a[68:71], v[32:35]
    v_and_b32 v76, v51, v4
    v_and_b32 v77, v51, v5
    v_and_b32_dpp v78, v51, v6 row_half_mirror row_mask:0xf bank_mask:0xf
    v_and_b32_dpp v79, v51, v7 row_half_mirror row_mask:0xf bank_mask:0xf
    v_mfma_f32_16x16x32_bf16 v[32:35], v[72:75], a[72:75], v[32:35]
    v_and_b32_dpp v80, v48, v4 row_half_mirror row_mask:0xf bank_mask:0xf
    v_and_b32_dpp v81, v48, v5 row_half_mirror row_mask:0xf bank_mask:0xf
    v_and_b32 v82, v48, v6
    v_and_b32 v83, v48, v7
    v_mfma_f32_16x16x32_bf16 v[32:35], v[76:79], a[76:79], v[32:35]
    v_and_b32_dpp v84, v49, v4 row_half_mirror row_mask:0xf bank_mask:0xf
    v_and_b32_dpp v85, v49, v5 row_half_mirror row_mask:0xf bank_mask:0xf
    v_and_b32 v86, v49, v6
    v_and_b32 v87, v49, v7
    v_mfma_f32_16x16x32_bf16 v[32:35], v[80:83], a[80:83], v[32:35]
    v_and_b32_dpp v88, v50, v4 row_half_mirror row_mask:0xf bank_mask:0xf
    v_and_b32_dpp v89, v50, v5 row_half_mirror row_mask:0xf bank_mask:0xf
    v_and_b32 v90, v50, v6
    v_and_b32 v91, v50, v7
    v_mfma_f32_16x16x32_bf16 v[32:35], v[84:87], a[84:87], v[32:35]
    v_and_b32_dpp v92, v51, v4 row_half_mirror row_mask:0xf bank_mask:0xf
    v_and_b32_dpp v93, v51, v5 row_half_mirror row_mask:0xf bank_mask:0xf
    v_and_b32_e64 v94, v51, v6
    v_and_b32 v95, v51, v7
    v_mfma_f32_16x16x32_bf16 v[32:35], v[88:91], a[88:91], v[32:35]
    s_cmp_lg_u32 s34, 0
    v_mfma_f32_16x16x32_bf16 v[32:35], v[92:95], a[92:95], v[32:35]
    s_nop 7
    ds_write_b128 v47, v[32:35] offset:4096
    s_waitcnt lgkmcnt(0)
    s_barrier
    s_cbranch_scc1 L_final
    ds_read_b128 v[16:19], v47 offset:5120
    ds_read_b128 v[20:23], v47 offset:6144
    ds_read_b128 v[24:27], v47 offset:7168
    v_pk_mul_f32 v[60:61], v[36:37], v[32:33] op_sel:[0,0] op_sel_hi:[0,1]
    v_pk_mul_f32 v[62:63], v[36:37], v[34:35] op_sel:[0,0] op_sel_hi:[0,1]
    s_waitcnt vmcnt(0)
    v_xor_b32 v52, s24, v52
    v_xor_b32 v53, s25, v53
    v_xor_b32 v54, s26, v54
    v_xor_b32_e64 v55, s27, v55
    v_or3_b32 v28, v52, v53, v54
    v_bitop3_b32 v28, v28, v55, s76 bitop3:0x54
    v_cmp_ne_u32 vcc, 0, v28
    s_waitcnt lgkmcnt(2)
    v_pk_fma_f32 v[60:61], v[36:37], v[16:17], v[60:61] op_sel:[0,0,0] op_sel_hi:[0,1,1]
    v_pk_fma_f32 v[62:63], v[36:37], v[18:19], v[62:63] op_sel:[0,0,0] op_sel_hi:[0,1,1]
    s_waitcnt lgkmcnt(1)
    v_pk_fma_f32 v[60:61], v[36:37], v[20:21], v[60:61] op_sel:[0,0,0] op_sel_hi:[0,1,1]
    v_pk_fma_f32 v[62:63], v[36:37], v[22:23], v[62:63] op_sel:[0,0,0] op_sel_hi:[0,1,1]
    s_waitcnt lgkmcnt(0)
    v_pk_fma_f32 v[60:61], v[36:37], v[24:25], v[60:61] op_sel:[0,0,0] op_sel_hi:[0,1,1]
    v_pk_fma_f32 v[62:63], v[36:37], v[26:27], v[62:63] op_sel:[0,0,0] op_sel_hi:[0,1,1]
L_yfchk:
    v_pk_add_f32 v[32:33], v[52:53], v[60:61]
    v_pk_add_f32 v[34:35], v[54:55], v[62:63]
    s_cbranch_vccnz L_yfretry
    v_and_or_b32 v32, v32, s76, v8
    v_and_or_b32 v33, v33, s76, v9
    v_and_or_b32 v34, v34, s76, v10
    v_and_or_b32 v35, v35, s76, v11
    global_store_dwordx4 v3, v[32:35], s[28:29] sc1
    s_endpgm
L_yfretry:
    buffer_load_dwordx4 v[52:55], v39, s[20:23], 0 offen sc1
    s_sub_u32 s77, s77, 1
    s_waitcnt vmcnt(0)
    v_xor_b32 v52, s24, v52
    v_xor_b32 v53, s25, v53
    v_xor_b32 v54, s26, v54
    v_xor_b32 v55, s27, v55
    v_or3_b32 v28, v52, v53, v54
    v_bitop3_b32 v28, v28, v55, s76 bitop3:0x54
    v_cmp_ne_u32 vcc, 0, v28
    s_cbranch_scc0 L_yfchk
    s_endpgm
L_notwo:
    s_cmp_eq_u32 s64, 1
    s_cbranch_scc1 L_ffn
    s_cmp_lt_u32 s15, 20
    s_cbranch_scc0 L_end
    s_waitcnt vmcnt(0)
L_gcchk:
    v_xor_b32 v37, s41, v37
    v_cmp_lt_u32 vcc, 1, v37
    s_cbranch_vccnz L_gcretry
    v_lshlrev_b32 v37, 13, v37
L_final:
    s_cmp_lt_u32 s15, 20
    s_cbranch_scc0 L_end
    s_lshr_b32 s78, s32, 4
    s_lshl_b32 s35, s15, 1
    s_cmp_ge_u32 s15, 10
    s_cselect_b32 s79, 19, 0
    s_sub_u32 s35, s35, s79
    s_lshr_b32 s79, s32, 3
    s_mul_i32 s65, s79, 20
    s_add_u32 s65, s65, s35
    s_mul_i32 s35, s78, 40
    s_sub_u32 s35, s65, s35
    s_lshr_b32 s67, s35, 3
    s_lshl_b32 s67, s67, 17
    s_add_u32 s67, s67, 1048576
    s_and_b32 s79, s35, 32
    s_xor_b32 s79, s79, 32
    s_lshl_b32 s79, s79, 9
    s_add_u32 s67, s67, s79
    s_and_b32 s35, s35, 7
    s_lshl_b32 s35, s35, 6
    s_or_b32 s67, s67, s35
    s_lshl_b32 s35, s78, 9
    s_or_b32 s67, s67, s35
    v_and_b32 v44, 3, v0
    v_lshrrev_b32 v45, 2, v0
    v_and_b32 v48, 7, v45
    v_lshlrev_b32 v48, 10, v48
    v_lshl_add_u32 v48, v44, 4, v48
    v_lshrrev_b32 v49, 3, v45
    v_lshl_add_u32 v48, v49, 15, v48
    v_and_b32 v49, 14, v45
    v_lshl_add_u32 v48, v49, 6, v48
    v_xor_b32 v48, s67, v48
    v_xor_b32 v48, v37, v48
    v_add_u32 v49, 65536, v48
    v_lshl_add_u32 v44, v44, 3, v1
    v_lshlrev_b32 v44, 1, v44
    s_and_b32 s66, s65, 3
    s_lshl_b32 s66, s66, 6
    s_and_b32 s35, s65, 4
    s_lshl_b32 s35, s35, 1
    s_add_u32 s66, s66, s35
    s_lshr_b32 s35, s65, 3
    s_lshl_b32 s35, s35, 8
    s_add_u32 s66, s66, s35
    buffer_load_ushort v45, v44, s[56:59], s66 offen
    global_load_dwordx4 v[64:67], v48, s[28:29] sc1
    global_load_dwordx4 v[68:71], v49, s[28:29] sc1
L_yloop2:
    global_load_dwordx4 v[72:75], v48, s[28:29] sc1
    global_load_dwordx4 v[76:79], v49, s[28:29] sc1
    s_sub_u32 s77, s77, 1
    s_cbranch_scc1 L_exit
    s_waitcnt vmcnt(2)
    v_xor_b32 v16, s60, v64
    v_xor_b32_e64 v17, s61, v65
    v_xor_b32 v18, s62, v66
    v_xor_b32 v19, s63, v67
    v_xor_b32 v20, s60, v68
    v_xor_b32 v21, s61, v69
    v_xor_b32 v22, s62, v70
    v_xor_b32 v23, s63, v71
    v_or3_b32 v32, v16, v17, v18
    v_or3_b32 v32, v32, v19, v20
    v_or3_b32 v32, v32, v21, v22
    v_bitop3_b32 v32, v32, v23, s76 bitop3:0x54
    v_cmp_ne_u32_e64 vcc, 0, v32
    v_pk_add_f32 v[16:17], v[16:17], v[20:21]
    v_pk_add_f32 v[18:19], v[18:19], v[22:23]
    s_and_b64 exec, exec, vcc
    s_cbranch_scc0 L_ydone
    global_load_dwordx4 v[64:67], v48, s[28:29] sc1
    global_load_dwordx4 v[68:71], v49, s[28:29] sc1
    s_waitcnt vmcnt(2)
    v_xor_b32 v16, s60, v72
    v_xor_b32_e64 v17, s61, v73
    v_xor_b32 v18, s62, v74
    v_xor_b32 v19, s63, v75
    v_xor_b32 v20, s60, v76
    v_xor_b32 v21, s61, v77
    v_xor_b32 v22, s62, v78
    v_xor_b32 v23, s63, v79
    v_or3_b32 v32, v16, v17, v18
    v_or3_b32 v32, v32, v19, v20
    v_or3_b32 v32, v32, v21, v22
    v_bitop3_b32 v32, v32, v23, s76 bitop3:0x54
    v_cmp_ne_u32_e64 vcc, 0, v32
    v_pk_add_f32 v[16:17], v[16:17], v[20:21]
    v_pk_add_f32 v[18:19], v[18:19], v[22:23]
    s_and_b64 exec, exec, vcc
    s_cbranch_scc1 L_yloop2
L_ydone:
    s_mov_b64 exec, -1
    v_permlane32_swap_b32 v16, v18
    v_permlane32_swap_b32_e64 v17, v19
    v_pk_add_f32 v[16:17], v[16:17], v[18:19]
    s_nop 1
    v_permlane16_swap_b32 v16, v17
    v_add_f32_e64 v16, v16, v17
    s_cmp_lg_u32 s65, 0
    s_nop 0
    v_add_f32_dpp v16, v16, v16 row_ror:8 row_mask:0xf bank_mask:0xf
    s_nop 1
    v_add_f32_dpp v16, v16, v16 row_ror:4 row_mask:0xf bank_mask:0xf
    s_mov_b64 exec, s[68:69]
    v_cvt_pk_bf16_f32 v16, v16, v16
    buffer_store_short v16, v44, s[56:59], s66 offen
    s_cbranch_scc0 L_epoch
L_end:
L_exit:
    s_endpgm
L_epoch:
    s_mov_b64 exec, 1
    v_mov_b32 v28, s36
    v_mov_b32 v29, s37
    v_mov_b32 v30, s38
    v_mov_b32 v31, s39
    v_mov_b32 v24, 0
    global_store_dwordx4 v24, v[28:31], s[28:29]
    s_endpgm
L_ffn:
    s_waitcnt vmcnt(8)
L_hchk:
    v_xor_b32 v28, s60, v28
    v_xor_b32 v29, s61, v29
    v_xor_b32 v30, s62, v30
    v_xor_b32 v31, s63, v31
    v_or3_b32 v20, v28, v29, v30
    v_bitop3_b32 v20, v20, v31, s76 bitop3:0x54
    v_cmp_ne_u32_e64 vcc, 0, v20
    s_cbranch_vccnz L_hretry
L_gfchk:
    v_xor_b32 v37, s41, v37
    v_cmp_lt_u32 vcc, 1, v37
    s_cbranch_vccnz L_gfretry
    v_and_b32 v36, 0xffff0000, v36
    v_cvt_pk_bf16_f32 v48, v28, v28
    v_cvt_pk_bf16_f32 v49, v29, v29
    v_cvt_pk_bf16_f32 v50, v30, v30
    v_cvt_pk_bf16_f32 v51, v31, v31
    v_and_b32 v64, v48, v4
    v_and_b32 v65, v48, v5
    v_and_b32_dpp v66, v48, v6 row_half_mirror row_mask:0xf bank_mask:0xf
    v_and_b32_dpp v67, v48, v7 row_half_mirror row_mask:0xf bank_mask:0xf
    v_and_b32 v68, v49, v4
    v_and_b32 v69, v49, v5
    v_and_b32_dpp v70, v49, v6 row_half_mirror row_mask:0xf bank_mask:0xf
    v_and_b32_dpp v71, v49, v7 row_half_mirror row_mask:0xf bank_mask:0xf
    v_and_b32 v72, v50, v4
    v_and_b32 v73, v50, v5
    v_and_b32_dpp v74, v50, v6 row_half_mirror row_mask:0xf bank_mask:0xf
    v_and_b32_dpp v75, v50, v7 row_half_mirror row_mask:0xf bank_mask:0xf
    v_and_b32 v76, v51, v4
    v_and_b32 v77, v51, v5
    v_and_b32_dpp v78, v51, v6 row_half_mirror row_mask:0xf bank_mask:0xf
    v_and_b32_dpp v79, v51, v7 row_half_mirror row_mask:0xf bank_mask:0xf
    v_and_b32_dpp v80, v48, v4 row_half_mirror row_mask:0xf bank_mask:0xf
    v_and_b32_dpp v81, v48, v5 row_half_mirror row_mask:0xf bank_mask:0xf
    v_and_b32 v82, v48, v6
    v_and_b32 v83, v48, v7
    v_and_b32_dpp v84, v49, v4 row_half_mirror row_mask:0xf bank_mask:0xf
    v_and_b32_dpp v85, v49, v5 row_half_mirror row_mask:0xf bank_mask:0xf
    v_and_b32 v86, v49, v6
    v_and_b32 v87, v49, v7
    v_and_b32_dpp v88, v50, v4 row_half_mirror row_mask:0xf bank_mask:0xf
    v_and_b32_dpp v89, v50, v5 row_half_mirror row_mask:0xf bank_mask:0xf
    v_and_b32 v90, v50, v6
    v_and_b32 v91, v50, v7
    v_and_b32_dpp v92, v51, v4 row_half_mirror row_mask:0xf bank_mask:0xf
    v_and_b32_dpp v93, v51, v5 row_half_mirror row_mask:0xf bank_mask:0xf
    v_and_b32 v94, v51, v6
    v_and_b32 v95, v51, v7
    s_waitcnt vmcnt(7)
    v_mfma_f32_16x16x32_bf16 v[32:35], v[64:67], a[64:67], 0
    s_waitcnt vmcnt(6)
    v_mfma_f32_16x16x32_bf16 v[32:35], v[68:71], a[68:71], v[32:35]
    s_waitcnt vmcnt(5)
    v_mfma_f32_16x16x32_bf16 v[32:35], v[72:75], a[72:75], v[32:35]
    s_waitcnt vmcnt(4)
    v_mfma_f32_16x16x32_bf16 v[32:35], v[76:79], a[76:79], v[32:35]
    s_waitcnt vmcnt(3)
    v_mfma_f32_16x16x32_bf16 v[32:35], v[80:83], a[80:83], v[32:35]
    s_waitcnt vmcnt(2)
    v_mfma_f32_16x16x32_bf16 v[32:35], v[84:87], a[84:87], v[32:35]
    s_waitcnt vmcnt(1)
    v_mfma_f32_16x16x32_bf16 v[32:35], v[88:91], a[88:91], v[32:35]
    s_waitcnt vmcnt(0)
    v_mfma_f32_16x16x32_bf16 v[32:35], v[92:95], a[92:95], v[32:35]
    s_bitcmp1_b32 s34, 0
    s_nop 6
    ds_write_b128 v47, v[32:35] offset:4096
    s_waitcnt lgkmcnt(0)
    s_barrier
    s_cbranch_scc1 L_end
    ds_read_b128 v[20:23], v47 offset:5120
    v_pk_mul_f32 v[32:33], v[36:37], v[32:33] op_sel:[0,0] op_sel_hi:[0,1]
    v_pk_mul_f32 v[34:35], v[36:37], v[34:35] op_sel:[0,0] op_sel_hi:[0,1]
    s_waitcnt lgkmcnt(0)
    v_pk_fma_f32 v[32:33], v[36:37], v[20:21], v[32:33] op_sel:[0,0,0] op_sel_hi:[0,1,1]
    v_pk_fma_f32 v[34:35], v[36:37], v[22:23], v[34:35] op_sel:[0,0,0] op_sel_hi:[0,1,1]
    v_and_or_b32 v32, v32, s76, v8
    v_and_or_b32 v33, v33, s76, v9
    v_and_or_b32 v34, v34, s76, v10
    v_and_or_b32 v35, v35, s76, v11
    global_store_dwordx4 v39, v[32:35], s[28:29]
    s_bitcmp1_b32 s31, 0
    s_cbranch_scc1 L_ypubfar
L_ypubnear:
    s_endpgm
L_nopl_do:
    v_and_b32 v55, 7, v0
    v_lshlrev_b32 v55, 8, v55
    v_lshrrev_b32 v54, 3, v0
    v_lshl_add_u32 v55, v54, 13, v55
    v_add_u32 v55, 983040, v55
    v_mov_b32 v54, 0
    s_mov_b64 exec, 0xffff
    global_store_dword v55, v54, s[28:29] sc1
    s_mov_b64 exec, -1
    s_branch L_nopl
L_noml_do:
    v_mov_b32 v16, 0
L_mlw:
    ds_read_b128 v[20:23], v16 offset:8192
    ds_read_b128 v[24:27], v16 offset:8208
    s_sub_u32 s77, s77, 1
    s_cbranch_scc1 L_exit
    s_waitcnt lgkmcnt(0)
    v_min3_u32 v17, v23, v25, v27
    v_cmp_eq_u32 vcc, 0, v17
    s_cbranch_vccnz L_mlw
    v_max3_f32 v16, v20, v22, v24
    v_max_f32 v16, v16, v26
    v_sub_f32 v40, v20, v16
    v_sub_f32 v41, v22, v16
    v_sub_f32 v42, v24, v16
    v_sub_f32 v43, v26, v16
    v_mul_f32 v40, s74, v40
    v_mul_f32 v41, s74, v41
    v_mul_f32 v42, s74, v42
    v_mul_f32 v43, s74, v43
    v_exp_f32 v40, v40
    v_exp_f32 v41, v41
    v_exp_f32 v42, v42
    v_exp_f32 v43, v43
    v_mul_f32 v18, v40, v21
    v_fmac_f32 v18, v41, v23
    v_fmac_f32 v18, v42, v25
    v_fmac_f32 v18, v43, v27
    v_mov_b32 v17, s36
    v_mov_b32 v19, s37
    v_mov_b32 v20, s75
    s_mov_b64 exec, 1
    s_bitcmp1_b32 s31, 0
    s_cbranch_scc1 L_mlpubfar
    global_store_dwordx4 v20, v[16:19], s[28:29]
L_mlpubnear:
    s_mov_b64 exec, -1
    s_branch L_noml
L_noha_do:
    v_and_b32 v46, 4, v2
    v_lshlrev_b32 v46, 2, v46
    v_lshl_add_u32 v46, v1, 5, v46
    s_lshl_b32 s78, s32, 1
    s_and_b32 s79, s34, 1
    s_add_u32 s78, s78, s79
    s_lshl_b32 s78, s78, 8
    s_add_u32 s78, s78, 589824
    v_and_b32 v44, 8, v2
    v_lshlrev_b32 v44, 4, v44
    v_add3_u32 v44, v44, s78, v46
    s_branch L_noha
L_nogp_do:
    global_load_dwordx4 v[48:51], v38, s[28:29] offset:0 sc1
    global_load_dwordx4 v[52:55], v38, s[28:29] offset:1024 sc1
    s_branch L_nogp
L_ng2_do:
    s_mov_b32 s41, 0
    s_mov_b32 s78, 983040
    s_mov_b32 s79, 991232
    s_mov_b32 s16, -1
    s_mov_b32 s17, -1
    s_mov_b32 s18, -1
    s_mov_b32 s19, -1
    s_mov_b32 s6, -1
    s_mov_b32 s7, -1
    s_mov_b32 s8, -1
    s_mov_b32 s9, -1
    s_mov_b32 s35, 48
    s_load_dword s16, s[28:29], s78
    s_load_dword s6, s[28:29], s79
    s_addk_i32 s78, 256
    s_addk_i32 s79, 256
    s_load_dword s7, s[28:29], s79
    s_load_dword s17, s[28:29], s78
    s_addk_i32 s78, 256
    s_addk_i32 s79, 256
    s_load_dword s18, s[28:29], s78
    s_load_dword s8, s[28:29], s79
    s_addk_i32 s78, 256
    s_addk_i32 s79, 256
    s_load_dword s9, s[28:29], s79
    s_load_dword s19, s[28:29], s78
    s_addk_i32 s78, 256
    s_addk_i32 s79, 256
L_rc0:
    s_mov_b64 s[10:11], 0
    s_cmp_eq_u32 s16, -1
    s_addc_u32 s10, s10, 0
    s_cmp_eq_u32 s6, -1
    s_addc_u32 s11, s11, 0
    s_cmp_eq_u32 s7, -1
    s_addc_u32 s11, s11, 0
    s_cmp_eq_u32 s17, -1
    s_addc_u32 s10, s10, 0
    s_cmp_eq_u32 s18, -1
    s_addc_u32 s10, s10, 0
    s_cmp_eq_u32 s8, -1
    s_addc_u32 s11, s11, 0
    s_cmp_eq_u32 s9, -1
    s_addc_u32 s11, s11, 0
    s_cmp_eq_u32 s19, -1
    s_addc_u32 s10, s10, 0
    s_add_u32 s41, s41, s10
    s_sub_u32 s41, s41, s11
    s_sub_u32 s35, s35, 1
    s_cbranch_scc1 L_rd0
    s_or_b32 s10, s10, s11
    s_cbranch_scc1 L_rc0
L_rd0:
    s_waitcnt lgkmcnt(0)
    s_mov_b32 s16, -1
    s_mov_b32 s17, -1
    s_mov_b32 s18, -1
    s_mov_b32 s19, -1
    s_mov_b32 s6, -1
    s_mov_b32 s7, -1
    s_mov_b32 s8, -1
    s_mov_b32 s9, -1
    s_mov_b32 s35, 48
    s_load_dword s6, s[28:29], s79
    s_load_dword s16, s[28:29], s78
    s_addk_i32 s78, 256
    s_addk_i32 s79, 256
    s_load_dword s17, s[28:29], s78
    s_load_dword s7, s[28:29], s79
    s_addk_i32 s78, 256
    s_addk_i32 s79, 256
    s_load_dword s8, s[28:29], s79
    s_load_dword s18, s[28:29], s78
    s_addk_i32 s78, 256
    s_addk_i32 s79, 256
    s_load_dword s19, s[28:29], s78
    s_load_dword s9, s[28:29], s79
    s_addk_i32 s78, 256
    s_addk_i32 s79, 256
L_rc1:
    s_mov_b64 s[10:11], 0
    s_cmp_eq_u32 s16, -1
    s_addc_u32 s10, s10, 0
    s_cmp_eq_u32 s6, -1
    s_addc_u32 s11, s11, 0
    s_cmp_eq_u32 s7, -1
    s_addc_u32 s11, s11, 0
    s_cmp_eq_u32 s17, -1
    s_addc_u32 s10, s10, 0
    s_cmp_eq_u32 s18, -1
    s_addc_u32 s10, s10, 0
    s_cmp_eq_u32 s8, -1
    s_addc_u32 s11, s11, 0
    s_cmp_eq_u32 s9, -1
    s_addc_u32 s11, s11, 0
    s_cmp_eq_u32 s19, -1
    s_addc_u32 s10, s10, 0
    s_add_u32 s41, s41, s10
    s_sub_u32 s41, s41, s11
    s_sub_u32 s35, s35, 1
    s_cbranch_scc1 L_rd1
    s_or_b32 s10, s10, s11
    s_cbranch_scc1 L_rc1
L_rd1:
    s_waitcnt lgkmcnt(0)
    s_cmp_gt_i32 s41, 0
    s_cselect_b32 s41, 1, 0
    s_waitcnt vmcnt(13)
    v_lshlrev_b32 v43, 16, v48
    v_lshlrev_b32 v41, 16, v56
    v_mul_f32 v43, v43, v41
    v_and_b32 v48, 0xffff0000, v48
    v_and_b32 v56, 0xffff0000, v56
    v_mul_f32 v41, v48, v56
    v_cvt_pk_bf16_f32 v48, v43, v41
    v_lshlrev_b32 v43, 16, v48
    v_and_b32 v41, 0xffff0000, v48
    v_add_f32 v42, v43, v41
    v_lshlrev_b32 v43, 16, v49
    v_lshlrev_b32 v41, 16, v57
    v_mul_f32 v43, v43, v41
    v_and_b32 v49, 0xffff0000, v49
    v_and_b32 v57, 0xffff0000, v57
    v_mul_f32 v41, v49, v57
    v_cvt_pk_bf16_f32 v49, v43, v41
    v_lshlrev_b32 v43, 16, v49
    v_and_b32 v41, 0xffff0000, v49
    v_add_f32 v42, v42, v43
    v_add_f32 v42, v42, v41
    v_lshlrev_b32 v43, 16, v50
    v_lshlrev_b32 v41, 16, v58
    v_mul_f32 v43, v43, v41
    v_and_b32 v50, 0xffff0000, v50
    v_and_b32 v58, 0xffff0000, v58
    v_mul_f32 v41, v50, v58
    v_cvt_pk_bf16_f32 v50, v43, v41
    v_lshlrev_b32 v43, 16, v50
    v_and_b32 v41, 0xffff0000, v50
    v_add_f32 v42, v42, v43
    v_add_f32 v42, v42, v41
    v_lshlrev_b32 v43, 16, v51
    v_lshlrev_b32 v41, 16, v59
    v_mul_f32 v43, v43, v41
    v_and_b32 v51, 0xffff0000, v51
    v_and_b32 v59, 0xffff0000, v59
    v_mul_f32 v41, v51, v59
    v_cvt_pk_bf16_f32 v51, v43, v41
    v_lshlrev_b32 v43, 16, v51
    v_and_b32 v41, 0xffff0000, v51
    v_add_f32 v42, v42, v43
    v_add_f32 v42, v42, v41
    v_lshlrev_b32 v43, 16, v52
    v_lshlrev_b32 v41, 16, v60
    v_mul_f32 v43, v43, v41
    v_and_b32 v52, 0xffff0000, v52
    v_and_b32 v60, 0xffff0000, v60
    v_mul_f32 v41, v52, v60
    v_cvt_pk_bf16_f32 v52, v43, v41
    v_lshlrev_b32 v43, 16, v52
    v_and_b32 v41, 0xffff0000, v52
    v_add_f32 v42, v42, v43
    v_add_f32 v42, v42, v41
    v_lshlrev_b32 v43, 16, v53
    v_lshlrev_b32 v41, 16, v61
    v_mul_f32 v43, v43, v41
    v_and_b32 v53, 0xffff0000, v53
    v_and_b32 v61, 0xffff0000, v61
    v_mul_f32 v41, v53, v61
    v_cvt_pk_bf16_f32 v53, v43, v41
    v_lshlrev_b32 v43, 16, v53
    v_and_b32 v41, 0xffff0000, v53
    v_add_f32 v42, v42, v43
    v_add_f32 v42, v42, v41
    v_lshlrev_b32 v43, 16, v54
    v_lshlrev_b32 v41, 16, v62
    v_mul_f32 v43, v43, v41
    v_and_b32 v54, 0xffff0000, v54
    v_and_b32 v62, 0xffff0000, v62
    v_mul_f32 v41, v54, v62
    v_cvt_pk_bf16_f32 v54, v43, v41
    v_lshlrev_b32 v43, 16, v54
    v_and_b32 v41, 0xffff0000, v54
    v_add_f32 v42, v42, v43
    v_add_f32 v42, v42, v41
    v_lshlrev_b32 v43, 16, v55
    v_lshlrev_b32 v41, 16, v63
    v_mul_f32 v43, v43, v41
    v_and_b32 v55, 0xffff0000, v55
    v_and_b32 v63, 0xffff0000, v63
    v_mul_f32 v41, v55, v63
    v_cvt_pk_bf16_f32 v55, v43, v41
    v_lshlrev_b32 v43, 16, v55
    v_and_b32 v41, 0xffff0000, v55
    v_add_f32 v42, v42, v43
    v_add_f32 v42, v42, v41
    v_lshlrev_b32 v43, 16, v16
    v_lshlrev_b32 v41, 16, v20
    v_mul_f32 v43, v43, v41
    v_and_b32 v16, 0xffff0000, v16
    v_and_b32 v20, 0xffff0000, v20
    v_mul_f32 v41, v16, v20
    v_cvt_pk_bf16_f32 v16, v43, v41
    v_lshlrev_b32 v43, 16, v16
    v_and_b32 v41, 0xffff0000, v16
    v_add_f32 v42, v42, v43
    v_add_f32 v42, v42, v41
    v_lshlrev_b32 v43, 16, v17
    v_lshlrev_b32 v41, 16, v21
    v_mul_f32 v43, v43, v41
    v_and_b32 v17, 0xffff0000, v17
    v_and_b32 v21, 0xffff0000, v21
    v_mul_f32 v41, v17, v21
    v_cvt_pk_bf16_f32 v17, v43, v41
    v_lshlrev_b32 v43, 16, v17
    v_and_b32 v41, 0xffff0000, v17
    v_add_f32 v42, v42, v43
    v_add_f32 v42, v42, v41
    v_lshlrev_b32 v43, 16, v18
    v_lshlrev_b32 v41, 16, v22
    v_mul_f32 v43, v43, v41
    v_and_b32 v18, 0xffff0000, v18
    v_and_b32 v22, 0xffff0000, v22
    v_mul_f32 v41, v18, v22
    v_cvt_pk_bf16_f32 v18, v43, v41
    v_lshlrev_b32 v43, 16, v18
    v_and_b32 v41, 0xffff0000, v18
    v_add_f32 v42, v42, v43
    v_add_f32 v42, v42, v41
    v_lshlrev_b32 v43, 16, v19
    v_lshlrev_b32 v41, 16, v23
    v_mul_f32 v43, v43, v41
    v_and_b32 v19, 0xffff0000, v19
    v_and_b32 v23, 0xffff0000, v23
    v_mul_f32 v41, v19, v23
    v_cvt_pk_bf16_f32 v19, v43, v41
    v_lshlrev_b32 v43, 16, v19
    v_and_b32 v41, 0xffff0000, v19
    v_add_f32 v42, v42, v43
    v_add_f32 v42, v42, v41
    s_nop 1
    v_add_f32_dpp v42, v42, v42 quad_perm:[1,0,3,2] row_mask:0xf bank_mask:0xf
    s_nop 1
    v_add_f32_dpp v42, v42, v42 quad_perm:[2,3,0,1] row_mask:0xf bank_mask:0xf
    s_nop 1
    v_add_f32_dpp v42, v42, v42 row_half_mirror row_mask:0xf bank_mask:0xf
    s_nop 1
    v_add_f32_dpp v42, v42, v42 row_mirror row_mask:0xf bank_mask:0xf
    s_nop 1
    v_add_f32_dpp v42, v42, v42 row_bcast:15 row_mask:0xa bank_mask:0xf
    v_cvt_pk_bf16_f32 v42, v42, v42
    v_lshlrev_b32 v42, 16, v42
    v_mul_f32 v42, 0xbfb8aa3b, v42
    v_exp_f32 v42, v42
    s_nop 0
    v_add_f32 v42, 1.0, v42
    v_rcp_f32 v42, v42
    s_nop 0
    v_cvt_pk_bf16_f32 v42, v42, v42
    v_lshlrev_b32 v42, 16, v42
    v_sub_f32 v43, 1.0, v42
    v_cvt_pk_bf16_f32 v48, v42, v43
    s_and_b32 s35, s38, -2
    s_or_b32 s35, s35, s41
    v_mov_b32 v49, s35
    v_lshrrev_b32 v52, 5, v0
    v_lshlrev_b32 v52, 3, v52
    v_add_u32 v52, 622592, v52
    v_writelane_b32 v52, 16, 0
    s_brev_b32 exec_hi, 1
    s_or_b32 exec_lo, exec_hi, 1
    global_store_dwordx2 v52, v[48:49], s[28:29] sc1
    s_mov_b64 exec, -1
    s_branch L_ng2
L_ng1_do:
    v_and_b32 v41, 31, v0
    v_lshlrev_b32 v41, 4, v41
    v_lshrrev_b32 v42, 5, v0
    v_mul_u32_u24 v42, 1280, v42
    v_add_u32 v42, v42, v41
    v_mov_b32 v16, 0
    v_mov_b32 v17, 0
    v_mov_b32 v18, 0
    v_mov_b32 v19, 0
    v_mov_b32 v20, 0
    v_mov_b32 v21, 0
    v_mov_b32 v22, 0
    v_mov_b32 v23, 0
    global_load_dwordx4 v[48:51], v42, s[4:5] offset:0
    global_load_dwordx4 v[56:59], v41, s[22:23] offset:0
    global_load_dwordx4 v[52:55], v42, s[4:5] offset:512
    global_load_dwordx4 v[60:63], v41, s[22:23] offset:512
    s_mov_b32 exec_lo, 0xffff
    s_mov_b32 exec_hi, exec_lo
    global_load_dwordx4 v[16:19], v42, s[4:5] offset:1024
    global_load_dwordx4 v[20:23], v41, s[22:23] offset:1024
    s_mov_b64 exec, -1
    s_branch L_ng1
L_noh_do:
    s_waitcnt vmcnt(13)
L_gchk:
    v_xor_b32 v48, s24, v48
    v_xor_b32 v49, s25, v49
    v_xor_b32 v50, s26, v50
    v_xor_b32 v51, s27, v51
    v_xor_b32 v52, s24, v52
    v_xor_b32 v53, s25, v53
    v_xor_b32 v54, s26, v54
    v_xor_b32 v55, s27, v55
    v_or3_b32 v37, v48, v49, v50
    v_or3_b32 v37, v37, v51, v52
    v_or3_b32 v37, v37, v53, v54
    v_bitop3_b32 v37, v37, v55, -16 bitop3:0x54
    v_cmp_ne_u32 vcc, 0, v37
    s_cbranch_vccnz L_gretry
    v_add_f32_dpp v48, v48, v48 quad_perm:[1,0,3,2] row_mask:0xf bank_mask:0xf
    v_add_f32_dpp v49, v49, v49 quad_perm:[1,0,3,2] row_mask:0xf bank_mask:0xf
    v_add_f32_dpp v50, v50, v50 quad_perm:[1,0,3,2] row_mask:0xf bank_mask:0xf
    v_add_f32_dpp v51, v51, v51 quad_perm:[1,0,3,2] row_mask:0xf bank_mask:0xf
    v_add_f32_dpp v52, v52, v52 quad_perm:[1,0,3,2] row_mask:0xf bank_mask:0xf
    v_add_f32_dpp v53, v53, v53 quad_perm:[1,0,3,2] row_mask:0xf bank_mask:0xf
    v_add_f32_dpp v54, v54, v54 quad_perm:[1,0,3,2] row_mask:0xf bank_mask:0xf
    v_add_f32_dpp v55, v55, v55 quad_perm:[1,0,3,2] row_mask:0xf bank_mask:0xf
    v_add_f32_dpp v48, v48, v48 quad_perm:[2,3,0,1] row_mask:0xf bank_mask:0xf
    v_add_f32_dpp v49, v49, v49 quad_perm:[2,3,0,1] row_mask:0xf bank_mask:0xf
    v_add_f32_dpp v50, v50, v50 quad_perm:[2,3,0,1] row_mask:0xf bank_mask:0xf
    v_add_f32_dpp v51, v51, v51 quad_perm:[2,3,0,1] row_mask:0xf bank_mask:0xf
    v_add_f32_dpp v52, v52, v52 quad_perm:[2,3,0,1] row_mask:0xf bank_mask:0xf
    v_add_f32_dpp v53, v53, v53 quad_perm:[2,3,0,1] row_mask:0xf bank_mask:0xf
    v_add_f32_dpp v54, v54, v54 quad_perm:[2,3,0,1] row_mask:0xf bank_mask:0xf
    v_add_f32_dpp v55, v55, v55 quad_perm:[2,3,0,1] row_mask:0xf bank_mask:0xf
    v_cvt_pk_bf16_f32 v56, v48, v49
    v_lshlrev_b32 v48, 16, v56
    v_and_b32 v49, 0xffff0000, v56
    v_cvt_pk_bf16_f32 v57, v50, v51
    v_lshlrev_b32 v50, 16, v57
    v_and_b32 v51, 0xffff0000, v57
    v_cvt_pk_bf16_f32 v58, v52, v53
    v_lshlrev_b32 v52, 16, v58
    v_and_b32 v53, 0xffff0000, v58
    v_cvt_pk_bf16_f32 v59, v54, v55
    v_lshlrev_b32 v54, 16, v59
    v_and_b32 v55, 0xffff0000, v59
    v_mov_b32 v60, 0xc0135761
    s_mov_b32 s35, 0xbdd2d3e8
    v_mul_f32 v56, v48, v48
    v_mul_f32 v57, v49, v49
    v_mul_f32 v58, v50, v50
    v_mul_f32 v59, v51, v51
    v_fma_f32 v56, v56, s35, v60
    v_fma_f32 v57, v57, s35, v60
    v_fma_f32 v58, v58, s35, v60
    v_fma_f32 v59, v59, s35, v60
    v_mul_f32 v56, v56, v48
    v_mul_f32 v57, v57, v49
    v_mul_f32 v58, v58, v50
    v_mul_f32 v59, v59, v51
    v_exp_f32 v56, v56
    v_exp_f32 v57, v57
    v_exp_f32 v58, v58
    v_exp_f32 v59, v59
    v_add_f32 v56, 1.0, v56
    v_add_f32 v57, 1.0, v57
    v_add_f32 v58, 1.0, v58
    v_add_f32 v59, 1.0, v59
    v_rcp_f32 v56, v56
    v_rcp_f32 v57, v57
    v_rcp_f32 v58, v58
    v_rcp_f32 v59, v59
    v_mul_f32 v48, v48, v56
    v_mul_f32 v49, v49, v57
    v_mul_f32 v50, v50, v58
    v_mul_f32 v51, v51, v59
    v_cvt_pk_bf16_f32 v56, v48, v49
    v_lshlrev_b32 v48, 16, v56
    v_and_b32 v49, 0xffff0000, v56
    v_cvt_pk_bf16_f32 v57, v50, v51
    v_lshlrev_b32 v50, 16, v57
    v_and_b32 v51, 0xffff0000, v57
    v_mul_f32 v48, v48, v52
    v_mul_f32 v49, v49, v53
    v_mul_f32 v50, v50, v54
    v_mul_f32 v51, v51, v55
    v_cvt_pk_bf16_f32 v56, v48, v49
    v_lshlrev_b32 v48, 16, v56
    v_and_b32 v49, 0xffff0000, v56
    v_cvt_pk_bf16_f32 v57, v50, v51
    v_lshlrev_b32 v50, 16, v57
    v_and_b32 v51, 0xffff0000, v57
    v_or_b32 v48, v48, v8
    v_or_b32 v49, v49, v9
    v_or_b32 v50, v50, v10
    v_or_b32 v51, v51, v11
    s_lshl_b32 s35, s32, 1
    s_and_b32 s78, s34, 1
    s_add_u32 s35, s35, s78
    s_lshl_b32 s35, s35, 8
    s_add_u32 s35, s35, 589824
    v_and_b32 v52, 8, v2
    v_lshlrev_b32 v52, 4, v52
    v_and_b32 v53, 4, v2
    v_lshl_add_u32 v52, v53, 2, v52
    v_lshl_add_u32 v52, v1, 5, v52
    v_add_u32 v52, s35, v52
    s_mov_b32 exec_lo, 0x11111111
    s_mov_b32 exec_hi, exec_lo
    global_store_dwordx4 v52, v[48:51], s[28:29]
    s_bitcmp1_b32 s31, 0
    s_cbranch_scc1 L_hpubfar
L_hpubnear:
    s_mov_b64 exec, -1
    s_branch L_noh
L_qslow:
    s_bitcmp1_b32 s31, 1
    s_cbranch_scc1 L_qs1
    s_bitset1_b32 s31, 1
    s_mov_b64 exec, s[42:43]
    global_store_dwordx4 v36, v[32:35], s[28:29] sc1
    s_mov_b64 exec, -1
L_qs1:
    v_and_b32 v19, -16, v19
    v_and_b32 v23, -16, v23
    v_or_b32 v37, v16, v17
    v_or3_b32 v37, v37, v18, v19
    v_or3_b32 v37, v37, v20, v21
    v_or3_b32 v37, v37, v22, v23
    v_and_b32 v37, 15, v37
    v_cmp_ne_u32 vcc, 0, v37
    s_cbranch_vccnz L_qretry
    s_bitset1_b32 s31, 0
    s_branch L_qok
L_qretry:
    global_load_dwordx4 v[16:19], v3, s[28:29] offset:-2048 sc1
    global_load_dwordx4 v[20:23], v3, s[28:29] offset:2048 sc1
    s_sub_u32 s77, s77, 1
    s_waitcnt vmcnt(0)
    s_cbranch_scc1 L_exit
    s_branch L_qchk
L_gretry:
    global_load_dwordx4 v[48:51], v38, s[28:29] offset:0 sc1
    global_load_dwordx4 v[52:55], v38, s[28:29] offset:1024 sc1
    s_sub_u32 s77, s77, 1
    s_waitcnt vmcnt(0)
    s_cbranch_scc1 L_exit
    s_branch L_gchk
L_hpubfar:
    global_store_dwordx4 v52, v[48:51], s[28:29] sc1
    s_branch L_hpubnear
L_mlpubfar:
    global_store_dwordx4 v20, v[16:19], s[28:29] sc1
    s_branch L_mlpubnear
L_opubfar:
    global_store_dwordx4 v46, v[32:35], s[28:29] sc1
    s_branch L_opubnear
L_mretry:
    global_load_dwordx4 v[28:31], v44, s[28:29] sc1
    s_sub_u32 s77, s77, 1
    s_waitcnt vmcnt(0)
    s_cbranch_scc1 L_exit
    s_branch L_mchk
L_garetry:
    global_load_dwordx2 v[36:37], v38, s[28:29] sc1
    s_sub_u32 s77, s77, 1
    s_waitcnt vmcnt(0)
    s_cbranch_scc1 L_exit
    s_branch L_gachk
L_gcretry:
    global_load_dwordx2 v[36:37], v38, s[28:29] sc1
    s_sub_u32 s77, s77, 1
    s_waitcnt vmcnt(0)
    s_cbranch_scc1 L_exit
    s_branch L_gcchk
L_hretry:
    global_load_dwordx4 v[28:31], v44, s[28:29] sc1
    s_sub_u32 s77, s77, 1
    s_waitcnt vmcnt(0)
    s_cbranch_scc1 L_exit
    s_branch L_hchk
L_gfretry:
    global_load_dwordx2 v[36:37], v38, s[28:29] sc1
    s_sub_u32 s77, s77, 1
    s_waitcnt vmcnt(0)
    s_cbranch_scc1 L_exit
    s_branch L_gfchk
L_ypubfar:
    global_store_dwordx4 v39, v[32:35], s[28:29] sc1
    s_branch L_ypubnear
L_last:
    s_endpgm
.section .rodata,"a"
.p2align 6
.amdhsa_kernel gated_mix__sliding_block_cached__geglu_ffn__decode_kernel
  .amdhsa_next_free_vgpr 256
  .amdhsa_next_free_sgpr 102
  .amdhsa_accum_offset 128
  .amdhsa_group_segment_fixed_size 0
  .amdhsa_kernarg_size 104
  .amdhsa_user_sgpr_count 2
  .amdhsa_user_sgpr_kernarg_segment_ptr 1
  .amdhsa_system_sgpr_workgroup_id_x 1
.end_amdhsa_kernel
```
